```python
import torch

def _softmax(x, axis=-1):
    return torch.softmax(x, dim=axis)
def _gelu(x):
    return torch.nn.functional.gelu(x, approximate="tanh")
def _silu(x):
    return torch.nn.functional.silu(x)
def _sigmoid(x):
    return torch.sigmoid(x)
def _layernorm(x, axis=-1, eps=1e-5):
    m = x.mean(dim=axis, keepdim=True)
    v = x.var(dim=axis, keepdim=True, unbiased=False)
    return (x - m) / torch.sqrt(v + eps)
def _scatter_add(tgt, idx, src, axis=0):
    return tgt.clone().index_add_(axis, idx, src)
def _segment_sum(src, seg, n):
    out = torch.zeros((n,) + src.shape[1:], dtype=src.dtype)
    return out.index_add_(0, seg, src)
def _pad(x, pw):
    flat = tuple(v for pair in reversed(pw) for v in pair)
    return torch.nn.functional.pad(x, flat)

kernel_name = 'parallel_sum__ssm_conv_s5__mixer_channel_mlp__prompt'

def setup_inputs():

    _w = (lambda a: (lambda t: t.to(torch.bfloat16) if t.is_floating_point() else t)(torch.as_tensor(a)))
    def _A_setup():
        B, S, D = 1, 2048, 576
        P = D
        Lambda_re = -0.5 * (lambda _x: torch.exp(torch.as_tensor(_x)))((lambda *s: torch.randn(*s, dtype=torch.bfloat16) * 0.2)(P))
        Lambda_im = (lambda *s: torch.randn(*s, dtype=torch.bfloat16) * 0.8)(P) * 1.0
        B_re = (lambda *s: torch.randn(*s, dtype=torch.bfloat16) * 0.2)(P, D) * (D ** -0.5)
        B_im = (lambda *s: torch.randn(*s, dtype=torch.bfloat16) * 0.2)(P, D) * (D ** -0.5)
        C_re = (lambda *s: torch.randn(*s, dtype=torch.bfloat16) * 0.2)(D, P) * (P ** -0.5)
        C_im = (lambda *s: torch.randn(*s, dtype=torch.bfloat16) * 0.2)(D, P) * (P ** -0.5)
        log_dt = (lambda *s: torch.randn(*s, dtype=torch.bfloat16) * 0.2)(P) * 0.3 - 2.0
        Dskip = (lambda *s: torch.randn(*s, dtype=torch.bfloat16) * 0.05)(D)
        return {
            "x": _w((lambda *s: torch.randn(*s, dtype=torch.bfloat16) * 0.05)(B, S, D)),
            "Lambda_re": _w(Lambda_re),
            "Lambda_im": _w(Lambda_im),
            "B_re": _w(B_re),
            "B_im": _w(B_im),
            "C_re": _w(C_re),
            "C_im": _w(C_im),
            "log_dt": _w(log_dt),
            "Dskip": _w(Dskip),
        }
    _A_in = _A_setup()

    def _B_setup():
        B, S, D, F = 1, 2048, 576, 4608
        return {
            "x": _w((lambda *s: torch.randn(*s, dtype=torch.bfloat16) * 0.05)(B, S, D)),
            "w1": _w((lambda *s: torch.randn(*s, dtype=torch.bfloat16) * 1.6)(D, F) * (D ** -0.5)),
            "b1": _w((lambda *s: torch.randn(*s, dtype=torch.bfloat16) * 0.8)(F)),
            "w2": _w((lambda *s: torch.randn(*s, dtype=torch.bfloat16) * 0.05)(F, D) * (F ** -0.5)),
            "b2": _w((lambda *s: torch.randn(*s, dtype=torch.bfloat16) * 0.05)(D)),
        }
    _B_in = _B_setup()

    return {
        "A_x": _A_in["x"],
        "A_Lambda_re": _A_in["Lambda_re"],
        "A_Lambda_im": _A_in["Lambda_im"],
        "A_B_re": _A_in["B_re"],
        "A_B_im": _A_in["B_im"],
        "A_C_re": _A_in["C_re"],
        "A_C_im": _A_in["C_im"],
        "A_log_dt": _A_in["log_dt"],
        "A_Dskip": _A_in["Dskip"],
        "B_x": _B_in["x"],
        "B_w1": _B_in["w1"],
        "B_b1": _B_in["b1"],
        "B_w2": _B_in["w2"],
        "B_b2": _B_in["b2"],
    }

def reference(A_x, A_Lambda_re, A_Lambda_im, A_B_re, A_B_im, A_C_re, A_C_im, A_log_dt, A_Dskip, B_x, B_w1, B_b1, B_w2, B_b2):
    def _A_ref(x, Lambda_re, Lambda_im, B_re, B_im, C_re, C_im, log_dt, Dskip):
        Bsz, L, H = x.shape
        Lam = Lambda_re + 1j * Lambda_im
        Bmat = B_re + 1j * B_im
        Cmat = C_re + 1j * C_im
        dt = torch.exp(log_dt)
        Lam_bar = torch.exp(dt * Lam)
        B_bar = ((Lam_bar - 1.0) / Lam)[:, None] * Bmat
        Bu = torch.einsum("bld,pd->blp", x + 0j, B_bar)
        h = torch.zeros_like(Bu[:, 0, :])
        hs = []
        for t in range(L):
            h = Lam_bar[None, :] * h + Bu[:, t, :]
            hs.append(h)
        hseq = torch.stack(hs, 1)
        y = 2.0 * torch.einsum("blp,dp->bld", hseq, Cmat).real + x * Dskip[None, None, :]
        return y

    def _B_ref(x, w1, b1, w2, b2):
        y = _layernorm(x, axis=-1)
        h = _gelu(torch.einsum("bsd,df->bsf", y, w1) + b1)
        return torch.einsum("bsf,fd->bsd", h, w2) + b2

    x = A_x
    xn = _layernorm(x, axis=-1)
    return x + _A_ref(xn, A_Lambda_re, A_Lambda_im, A_B_re, A_B_im, A_C_re, A_C_im, A_log_dt, A_Dskip) + _B_ref(xn, B_w1, B_b1, B_w2, B_b2)
```

```asm
; @launch grid=(256,1,1) block=(512,1,1) lds=163840
.amdgcn_target "amdgcn-amd-amdhsa--gfx950"
.text
.globl parallel_sum__ssm_conv_s5__mixer_channel_mlp__prompt_kernel
.p2align 8
.type parallel_sum__ssm_conv_s5__mixer_channel_mlp__prompt_kernel,@function
parallel_sum__ssm_conv_s5__mixer_channel_mlp__prompt_kernel:
    s_cmp_ge_u32 s2, 256
    s_cbranch_scc1 L_end
    s_load_dwordx16 s[32:47], s[0:1], 0
    s_load_dwordx16 s[48:63], s[0:1], 64
    s_load_dwordx2 s[64:65], s[0:1], 128
    v_lshrrev_b32 v15, 6, v0
    v_and_b32 v1, 63, v0
    v_readfirstlane_b32 s93, v15
    s_and_b32 s74, s2, 7
    s_lshr_b32 s75, s2, 3
    s_and_b32 s87, s75, 7
    s_lshr_b32 s76, s74, 2
    s_lshl_b32 s76, s76, 3
    s_add_u32 s6, s76, s87
    s_and_b32 s74, s74, 3
    s_lshr_b32 s75, s75, 3
    s_lshl_b32 s7, s74, 2
    s_add_u32 s7, s7, s75
    s_mul_i32 s81, s74, 3
    s_add_u32 s81, s81, s75
    s_sub_u32 s81, s81, 1
    s_cmp_eq_u32 s75, 0
    s_cselect_b32 s86, 1, 0
    s_cselect_b32 s81, s74, s81
    s_lshl_b32 s75, s75, 1
    s_xor_b32 s3, s93, s75
    s_and_b32 s4, s3, 3
    s_lshr_b32 s5, s3, 2
    s_lshl_b32 s66, s3, 10
    s_mov_b32 s79, 0xffff0000
    v_lshrrev_b32 v16, 2, v1
    s_lshl_b32 s76, s4, 5
    s_lshl_b32 s77, s5, 4
    s_add_u32 s77, s77, s76
    v_add_u32 v17, s77, v16
    s_cmp_eq_u32 s86, 0
    s_cbranch_scc1 L_tok_done
    v_lshrrev_b32 v18, 2, v16
    v_lshlrev_b32 v18, 3, v18
    v_and_b32 v17, 3, v16
    v_add_u32 v17, v17, v18
    s_lshl_b32 s77, s5, 2
    s_add_u32 s77, s77, s76
    v_add_u32 v17, s77, v17
L_tok_done:
    v_and_b32 v20, 3, v1
    v_mul_u32_u24 v19, 1152, v17
    v_lshl_add_u32 v19, v20, 4, v19
    s_mul_i32 s75, s6, 147456
    s_waitcnt lgkmcnt(0)
    s_mov_b32 s8, s32
    s_mov_b32 s9, s33
    s_mov_b32 s10, 2359296
    s_mov_b32 s11, 0x20000
    s_mov_b32 s92, s75
    s_cmp_ge_u32 s93, 4
    s_cbranch_scc1 L_x1
    buffer_load_dwordx4 v[112:115], v19, s[8:11], s92 offen offset:0
    buffer_load_dwordx4 v[120:123], v19, s[8:11], s92 offen offset:64
    buffer_load_dwordx4 v[128:131], v19, s[8:11], s92 offen offset:128
    buffer_load_dwordx4 v[136:139], v19, s[8:11], s92 offen offset:192
    buffer_load_dwordx4 v[144:147], v19, s[8:11], s92 offen offset:256
    buffer_load_dwordx4 v[152:155], v19, s[8:11], s92 offen offset:320
    buffer_load_dwordx4 v[160:163], v19, s[8:11], s92 offen offset:384
    buffer_load_dwordx4 v[168:171], v19, s[8:11], s92 offen offset:448
    buffer_load_dwordx4 v[176:179], v19, s[8:11], s92 offen offset:512
    buffer_load_dwordx4 v[184:187], v19, s[8:11], s92 offen offset:576
    buffer_load_dwordx4 v[192:195], v19, s[8:11], s92 offen offset:640
    buffer_load_dwordx4 v[200:203], v19, s[8:11], s92 offen offset:704
    buffer_load_dwordx4 v[208:211], v19, s[8:11], s92 offen offset:768
    buffer_load_dwordx4 v[216:219], v19, s[8:11], s92 offen offset:832
    buffer_load_dwordx4 v[224:227], v19, s[8:11], s92 offen offset:896
    buffer_load_dwordx4 v[232:235], v19, s[8:11], s92 offen offset:960
    buffer_load_dwordx4 v[240:243], v19, s[8:11], s92 offen offset:1024
    buffer_load_dwordx4 v[248:251], v19, s[8:11], s92 offen offset:1088
L_x1:
    s_mov_b32 s20, s64
    s_mov_b32 s21, s65
    s_mov_b32 s22, 268435456
    s_mov_b32 s23, 0x20000
    s_mov_b32 s24, s60
    s_mov_b32 s25, s61
    s_mov_b32 s26, 4718592
    s_mov_b32 s27, 0x20000
    s_mov_b32 s28, s62
    s_mov_b32 s29, s63
    s_mov_b32 s30, 256
    s_mov_b32 s31, 0x20000
    s_cmp_eq_u32 s86, 1
    s_cbranch_scc1 L_ft_ssm
    s_mov_b32 s12, s52
    s_mov_b32 s13, s53
    s_mov_b32 s14, 5308416
    s_mov_b32 s15, 0x20000
    s_mov_b32 s16, s56
    s_mov_b32 s17, s57
    s_mov_b32 s18, 5308416
    s_mov_b32 s19, 0x20000
    s_mul_i32 s67, s81, 768
    s_mul_i32 s85, s81, 442368
    s_branch L_ft_go
L_ft_ssm:
    s_bitcmp1_b32 s3, 1
    s_cselect_b32 s12, s40, s38
    s_cselect_b32 s13, s41, s39
    s_mov_b32 s14, 663552
    s_mov_b32 s15, 0x20000
    s_bitcmp1_b32 s3, 2
    s_cselect_b32 s16, s44, s42
    s_cselect_b32 s17, s45, s43
    s_mov_b32 s18, 663552
    s_mov_b32 s19, 0x20000
    s_mul_i32 s67, s81, 165888
    s_mul_i32 s85, s81, 288
L_ft_go:
    v_lshlrev_b32 v18, 1, v20
    v_xor_b32 v18, v18, v16
    v_lshl_add_u32 v18, v20, 4, v18
    v_lshlrev_b32 v12, 4, v18
    v_lshrrev_b32 v21, 4, v1
    v_and_b32 v22, 15, v1
    v_lshlrev_b32 v18, 1, v21
    v_xor_b32 v18, v18, v1
    v_lshlrev_b32 v11, 4, v18
    v_lshrrev_b32 v18, 3, v22
    s_mov_b32 s76, 151552
    s_bitcmp1_b32 s7, 2
    s_cselect_b32 s76, 143360, s76
    v_mul_u32_u24 v13, s76, v18
    s_mov_b32 s89, 303104
    s_bitcmp1_b32 s7, 3
    s_cselect_b32 s89, 286720, s89
    v_and_b32 v18, 7, v22
    v_lshl_add_u32 v18, v21, 3, v18
    v_lshl_add_u32 v13, v18, 4, v13
    s_lshl_b32 s76, s5, 9
    v_add_u32 v13, s76, v13
    s_lshl_b32 s76, s6, 4
    s_lshl_b32 s77, s4, 2
    s_add_u32 s76, s76, s77
    s_mul_i32 s84, s76, 147456
    s_lshl_b32 s76, s7, 10
    s_add_u32 s84, s84, s76
    s_cmp_eq_u32 s86, 1
    s_cbranch_scc1 L_ssm_setup
    v_lshrrev_b32 v24, 3, v1
    v_and_b32 v25, 7, v1
    v_and_b32 v18, 6, v24
    v_xor_b32 v25, v25, v18
    v_lshlrev_b32 v25, 4, v25
    s_lshl_b32 s76, s3, 3
    v_add_u32 v18, s76, v24
    v_mul_u32_u24 v3, 1152, v18
    v_add_u32 v3, v3, v25
    v_and_b32 v23, 35, v18
    v_and_b32 v2, 12, v18
    v_lshl_add_u32 v23, v2, 1, v23
    v_and_b32 v2, 16, v18
    v_lshrrev_b32 v2, 2, v2
    v_add_u32 v23, v23, v2
    v_mul_u32_u24 v2, 9216, v23
    v_add_u32 v2, v2, v25
    v_lshrrev_b32 v18, 2, v1
    v_lshrrev_b32 v23, 1, v18
    v_and_b32 v23, 3, v23
    s_lshl_b32 s76, s5, 1
    v_xor_b32 v23, s76, v23
    v_lshlrev_b32 v23, 5, v23
    v_lshl_add_u32 v4, v18, 7, v23
    v_and_b32 v23, 3, v1
    v_lshl_add_u32 v4, v23, 3, v4
    v_xor_b32 v5, 32, v4
    v_add_u32 v6, 49152, v4
    v_add_u32 v7, 49152, v5
    s_lshl_b32 s76, s5, 7
    s_add_u32 s76, s76, 155648
    v_lshlrev_b32 v8, 4, v21
    v_add_u32 v8, s76, v8
    s_lshl_b32 s76, s5, 13
    s_lshl_b32 s77, s4, 11
    s_add_u32 s76, s76, s77
    s_add_u32 s76, s76, 73728
    v_lshlrev_b32 v9, 4, v1
    v_add_u32 v9, s76, v9
    s_mov_b32 s80, 0xc09d30fc
    s_and_b32 s77, s93, 1
    s_mul_i32 s98, s87, 55296
    s_mul_i32 s75, s77, 128
    s_add_u32 s98, s98, s75
    s_add_u32 s98, s98, s85
    s_mul_i32 s76, s87, 663552
    s_mul_i32 s75, s77, 331776
    s_add_u32 s76, s76, s75
    s_add_u32 s76, s76, s67
    s_add_u32 s76, s76, 384
    s_mov_b32 s51, 256
    s_mov_b32 s99, 9216
    s_cmp_lt_u32 s93, 2
    s_cselect_b32 s98, s98, s76
    s_cselect_b32 s51, s51, 0x80
    s_cselect_b32 s99, 1152, s99
    s_cselect_b32 s36, s16, s12
    s_cselect_b32 s37, s17, s13
    s_cselect_b32 s38, s18, s14
    s_mov_b32 s39, 0x20000
    s_mov_b32 s68, s52
    s_mov_b32 s69, s53
    s_mov_b32 s70, 5308416
    s_mov_b32 s71, 0x20000
    v_mov_b32 v14, v2
    s_mov_b32 s73, 589824
    s_branch L_ln
L_ssm_setup:
    v_lshrrev_b32 v24, 3, v1
    s_and_b32 s76, s3, 1
    s_lshl_b32 s77, s76, 3
    v_add_u32 v24, s77, v24
    v_lshrrev_b32 v18, 1, v24
    v_and_b32 v25, 7, v1
    v_xor_b32 v25, v25, v18
    s_lshl_b32 s77, s5, 4
    v_add_u32 v24, s77, v24
    v_mul_u32_u24 v2, 1152, v24
    v_lshl_add_u32 v2, v25, 4, v2
    v_subrev_u32 v18, 256, v0
    v_min_u32 v18, 143, v18
    s_mul_i32 s76, s81, 144
    v_add_lshl_u32 v14, v18, s76, 1
    v_lshrrev_b32 v18, 1, v22
    v_xor_b32 v18, v18, v21
    v_lshlrev_b32 v18, 4, v18
    v_lshl_add_u32 v4, v22, 7, v18
    s_lshl_b32 s76, s5, 12
    v_add_u32 v4, s76, v4
    v_xor_b32 v5, 64, v4
    v_add_u32 v6, 49152, v4
    v_add_u32 v7, 49152, v5
L_ln:
    v_lshrrev_b32 v23, 2, v22
    v_cmp_eq_u32 vcc, v23, v21
    v_mov_b32 v23, 0x3f803f80
    v_mov_b32 v68, 0
    v_mov_b32 v69, 0
    v_mov_b32 v72, 0
    v_mov_b32 v73, 0
    v_cndmask_b32 v64, 0, v23, vcc
    v_cndmask_b32 v65, 0, v23, vcc
    v_cndmask_b32 v66, 0, v23, vcc
    v_cndmask_b32 v67, 0, v23, vcc
    v_and_b32 v23, 1, v22
    v_lshlrev_b32 v23, 4, v23
    v_mov_b32 v74, 0xffff
    v_lshlrev_b32 v23, v23, v74
    v_and_b32 v74, v23, v64
    v_and_b32 v23, 2, v22
    v_cmp_eq_u32 vcc, 0, v23
    s_nop 1
    v_cndmask_b32 v70, 0, v74, vcc
    v_cndmask_b32 v71, v74, v68, vcc
    s_lshl_b32 s76, s4, 1
    s_add_u32 s77, s76, s5
    s_lshl_b32 s75, s77, 10
    s_add_u32 s75, s75, 24576
    v_add_u32 v12, s75, v12
    v_add_u32 v18, 65536, v12
    s_lshl_b32 s75, s76, 10
    s_add_u32 s75, s75, 24576
    v_add_u32 v11, s75, v11
    v_mov_b32 v36, 0
    v_mov_b32 v37, 0
    s_cmp_lt_u32 s93, 4
    s_cbranch_scc1 L_x2
    s_cmp_lg_u32 s93, 7
    s_cbranch_scc1 L_cp0
    s_getpc_b64 s[90:91]
L_cp0pc:
    s_lshl_b32 s75, s87, 7
    v_lshlrev_b32 v62, 10, v1
    v_add_u32 v62, s75, v62
    v_min_u32 v62, L_last-L_cp0pc, v62
    global_load_dword v60, v62, s[90:91]
L_cp0:
    buffer_load_dwordx4 v[112:115], v19, s[8:11], s92 offen offset:0
    buffer_load_dwordx4 v[120:123], v19, s[8:11], s92 offen offset:64
    buffer_load_dwordx4 v[128:131], v19, s[8:11], s92 offen offset:128
    buffer_load_dwordx4 v[136:139], v19, s[8:11], s92 offen offset:192
    buffer_load_dwordx4 v[144:147], v19, s[8:11], s92 offen offset:256
    buffer_load_dwordx4 v[152:155], v19, s[8:11], s92 offen offset:320
    buffer_load_dwordx4 v[160:163], v19, s[8:11], s92 offen offset:384
    buffer_load_dwordx4 v[168:171], v19, s[8:11], s92 offen offset:448
    buffer_load_dwordx4 v[176:179], v19, s[8:11], s92 offen offset:512
    buffer_load_dwordx4 v[184:187], v19, s[8:11], s92 offen offset:576
    buffer_load_dwordx4 v[192:195], v19, s[8:11], s92 offen offset:640
    buffer_load_dwordx4 v[200:203], v19, s[8:11], s92 offen offset:704
    buffer_load_dwordx4 v[208:211], v19, s[8:11], s92 offen offset:768
    buffer_load_dwordx4 v[216:219], v19, s[8:11], s92 offen offset:832
    buffer_load_dwordx4 v[224:227], v19, s[8:11], s92 offen offset:896
    buffer_load_dwordx4 v[232:235], v19, s[8:11], s92 offen offset:960
    buffer_load_dwordx4 v[240:243], v19, s[8:11], s92 offen offset:1024
    buffer_load_dwordx4 v[248:251], v19, s[8:11], s92 offen offset:1088
L_x2:
    s_waitcnt vmcnt(16)
    v_mfma_f32_16x16x32_bf16 v[32:35], v[64:67], v[112:115], 0
    v_mfma_f32_16x16x32_bf16 v[32:35], v[64:67], v[120:123], v[32:35]
    s_waitcnt vmcnt(14)
    v_mfma_f32_16x16x32_bf16 v[32:35], v[64:67], v[128:131], v[32:35]
    v_mfma_f32_16x16x32_bf16 v[32:35], v[64:67], v[136:139], v[32:35]
    s_waitcnt vmcnt(12)
    v_mfma_f32_16x16x32_bf16 v[32:35], v[64:67], v[144:147], v[32:35]
    v_mfma_f32_16x16x32_bf16 v[32:35], v[64:67], v[152:155], v[32:35]
    s_waitcnt vmcnt(10)
    v_mfma_f32_16x16x32_bf16 v[32:35], v[64:67], v[160:163], v[32:35]
    v_mfma_f32_16x16x32_bf16 v[32:35], v[64:67], v[168:171], v[32:35]
    s_waitcnt vmcnt(8)
    v_mfma_f32_16x16x32_bf16 v[32:35], v[64:67], v[176:179], v[32:35]
    v_mfma_f32_16x16x32_bf16 v[32:35], v[64:67], v[184:187], v[32:35]
    s_waitcnt vmcnt(6)
    v_mfma_f32_16x16x32_bf16 v[32:35], v[64:67], v[192:195], v[32:35]
    v_mfma_f32_16x16x32_bf16 v[32:35], v[64:67], v[200:203], v[32:35]
    s_waitcnt vmcnt(4)
    v_mfma_f32_16x16x32_bf16 v[32:35], v[64:67], v[208:211], v[32:35]
    v_mfma_f32_16x16x32_bf16 v[32:35], v[64:67], v[216:219], v[32:35]
    s_waitcnt vmcnt(2)
    v_mfma_f32_16x16x32_bf16 v[32:35], v[64:67], v[224:227], v[32:35]
    v_mfma_f32_16x16x32_bf16 v[32:35], v[64:67], v[232:235], v[32:35]
    s_waitcnt vmcnt(0)
    v_mfma_f32_16x16x32_bf16 v[32:35], v[64:67], v[240:243], v[32:35]
    v_mfma_f32_16x16x32_bf16 v[32:35], v[64:67], v[248:251], v[32:35]
    v_dot2c_f32_bf16 v36, v112, v112
    v_dot2c_f32_bf16 v37, v113, v113
    v_dot2c_f32_bf16 v36, v114, v114
    v_dot2c_f32_bf16 v37, v115, v115
    v_dot2c_f32_bf16 v36, v120, v120
    v_dot2c_f32_bf16 v37, v121, v121
    v_dot2c_f32_bf16 v36, v122, v122
    v_dot2c_f32_bf16 v37, v123, v123
    v_dot2c_f32_bf16 v36, v128, v128
    v_dot2c_f32_bf16 v37, v129, v129
    v_dot2c_f32_bf16 v36, v130, v130
    v_dot2c_f32_bf16 v37, v131, v131
    v_dot2c_f32_bf16 v36, v136, v136
    v_dot2c_f32_bf16 v37, v137, v137
    v_dot2c_f32_bf16 v36, v138, v138
    v_dot2c_f32_bf16 v37, v139, v139
    v_dot2c_f32_bf16 v36, v144, v144
    v_dot2c_f32_bf16 v37, v145, v145
    v_dot2c_f32_bf16 v36, v146, v146
    v_dot2c_f32_bf16 v37, v147, v147
    v_dot2c_f32_bf16 v36, v152, v152
    v_dot2c_f32_bf16 v37, v153, v153
    v_dot2c_f32_bf16 v36, v154, v154
    v_dot2c_f32_bf16 v37, v155, v155
    v_dot2c_f32_bf16 v36, v160, v160
    v_dot2c_f32_bf16 v37, v161, v161
    v_dot2c_f32_bf16 v36, v162, v162
    v_dot2c_f32_bf16 v37, v163, v163
    v_dot2c_f32_bf16 v36, v168, v168
    v_dot2c_f32_bf16 v37, v169, v169
    v_dot2c_f32_bf16 v36, v170, v170
    v_dot2c_f32_bf16 v37, v171, v171
    v_dot2c_f32_bf16 v36, v176, v176
    v_dot2c_f32_bf16 v37, v177, v177
    v_dot2c_f32_bf16 v36, v178, v178
    v_dot2c_f32_bf16 v37, v179, v179
    v_dot2c_f32_bf16 v36, v184, v184
    v_dot2c_f32_bf16 v37, v185, v185
    v_dot2c_f32_bf16 v36, v186, v186
    v_dot2c_f32_bf16 v37, v187, v187
    v_dot2c_f32_bf16 v36, v192, v192
    v_dot2c_f32_bf16 v37, v193, v193
    v_dot2c_f32_bf16 v36, v194, v194
    v_dot2c_f32_bf16 v37, v195, v195
    v_dot2c_f32_bf16 v36, v200, v200
    v_dot2c_f32_bf16 v37, v201, v201
    v_dot2c_f32_bf16 v36, v202, v202
    v_dot2c_f32_bf16 v37, v203, v203
    v_dot2c_f32_bf16 v36, v208, v208
    v_dot2c_f32_bf16 v37, v209, v209
    v_dot2c_f32_bf16 v36, v210, v210
    v_dot2c_f32_bf16 v37, v211, v211
    v_dot2c_f32_bf16 v36, v216, v216
    v_dot2c_f32_bf16 v37, v217, v217
    v_dot2c_f32_bf16 v36, v218, v218
    v_dot2c_f32_bf16 v37, v219, v219
    v_dot2c_f32_bf16 v36, v224, v224
    v_dot2c_f32_bf16 v37, v225, v225
    v_dot2c_f32_bf16 v36, v226, v226
    v_dot2c_f32_bf16 v37, v227, v227
    v_dot2c_f32_bf16 v36, v232, v232
    v_dot2c_f32_bf16 v37, v233, v233
    v_dot2c_f32_bf16 v36, v234, v234
    v_dot2c_f32_bf16 v37, v235, v235
    v_dot2c_f32_bf16 v36, v240, v240
    v_dot2c_f32_bf16 v37, v241, v241
    v_dot2c_f32_bf16 v36, v242, v242
    v_dot2c_f32_bf16 v37, v243, v243
    v_dot2c_f32_bf16 v36, v248, v248
    v_dot2c_f32_bf16 v37, v249, v249
    v_dot2c_f32_bf16 v36, v250, v250
    v_dot2c_f32_bf16 v37, v251, v251
    v_add_u32 v19, 65536, v11
    v_add_f32_dpp v32, v32, v32 quad_perm:[1,0,3,2] row_mask:0xf bank_mask:0xf
    s_nop 0
    v_add_f32 v36, v36, v37
    v_add_f32_dpp v32, v32, v32 quad_perm:[2,3,0,1] row_mask:0xf bank_mask:0xf
    v_mul_f32 v38, 0x3ae38e39, v32
    v_add_f32_dpp v36, v36, v36 quad_perm:[1,0,3,2] row_mask:0xf bank_mask:0xf
    v_cvt_pk_bf16_f32 v40, v38, v38
    v_and_b32 v40, s79, v40
    s_cmp_eq_u32 s86, 1
    s_cselect_b64 vcc, -1, 0
    v_cndmask_b32 v42, v38, v40, vcc
    v_add_f32_dpp v36, v36, v36 quad_perm:[2,3,0,1] row_mask:0xf bank_mask:0xf
    v_sub_f32 v44, 0, v42
    v_sub_f32 v45, 0, v42
    v_sub_f32 v46, 0, v42
    v_sub_f32 v47, 0, v42
    s_nop 1
    v_mfma_f32_16x16x32_bf16 v[116:119], v[70:73], v[112:115], v[44:47]
    v_mfma_f32_16x16x32_bf16 v[80:83], v[68:71], v[112:115], v[44:47]
    v_mul_f32 v39, 0x3ae38e39, v36
    v_fma_f32 v39, -v38, v38, v39
    v_max_f32 v39, 0, v39
    v_cvt_pk_bf16_f32 v42, v39, v39
    v_and_b32 v42, s79, v42
    v_add_f32 v42, 0x3727c5ac, v42
    v_cvt_pk_bf16_f32 v42, v42, v42
    v_and_b32 v42, s79, v42
    v_mfma_f32_16x16x32_bf16 v[124:127], v[70:73], v[120:123], v[44:47]
    v_mfma_f32_16x16x32_bf16 v[84:87], v[68:71], v[120:123], v[44:47]
    v_sqrt_f32 v42, v42
    s_nop 0
    v_cvt_pk_bf16_f32 v42, v42, v42
    v_and_b32 v42, s79, v42
    v_rcp_f32 v41, v42
    s_nop 0
    v_mul_f32 v42, v39, v41
    v_mul_f32 v42, v42, v41
    v_mfma_f32_16x16x32_bf16 v[132:135], v[70:73], v[128:131], v[44:47]
    v_mfma_f32_16x16x32_bf16 v[88:91], v[68:71], v[128:131], v[44:47]
    v_cvt_pk_bf16_f32 v42, v42, v42
    v_cvt_pk_bf16_f32 v112, v116, v117
    v_cvt_pk_bf16_f32 v113, v118, v119
    v_cvt_pk_bf16_f32 v114, v80, v81
    v_cvt_pk_bf16_f32 v115, v82, v83
    ds_write_b128 v12, v[112:115] offset:0
    v_mfma_f32_16x16x32_bf16 v[140:143], v[70:73], v[136:139], v[44:47]
    v_mfma_f32_16x16x32_bf16 v[92:95], v[68:71], v[136:139], v[44:47]
    v_and_b32 v42, s79, v42
    v_cvt_pk_bf16_f32 v120, v124, v125
    v_cvt_pk_bf16_f32 v121, v126, v127
    v_cvt_pk_bf16_f32 v122, v84, v85
    v_cvt_pk_bf16_f32 v123, v86, v87
    ds_write_b128 v12, v[120:123] offset:8192
    v_mfma_f32_16x16x32_bf16 v[148:151], v[70:73], v[144:147], v[44:47]
    v_mfma_f32_16x16x32_bf16 v[80:83], v[68:71], v[144:147], v[44:47]
    v_add_f32 v42, 0x3727c5ac, v42
    v_cvt_pk_bf16_f32 v128, v132, v133
    v_cvt_pk_bf16_f32 v129, v134, v135
    v_cvt_pk_bf16_f32 v130, v88, v89
    v_cvt_pk_bf16_f32 v131, v90, v91
    ds_write_b128 v12, v[128:131] offset:16384
    v_mfma_f32_16x16x32_bf16 v[156:159], v[70:73], v[152:155], v[44:47]
    v_mfma_f32_16x16x32_bf16 v[84:87], v[68:71], v[152:155], v[44:47]
    v_cvt_pk_bf16_f32 v42, v42, v42
    v_cvt_pk_bf16_f32 v136, v140, v141
    v_cvt_pk_bf16_f32 v137, v142, v143
    v_cvt_pk_bf16_f32 v138, v92, v93
    v_cvt_pk_bf16_f32 v139, v94, v95
    ds_write_b128 v12, v[136:139] offset:24576
    v_mfma_f32_16x16x32_bf16 v[164:167], v[70:73], v[160:163], v[44:47]
    v_mfma_f32_16x16x32_bf16 v[88:91], v[68:71], v[160:163], v[44:47]
    v_and_b32 v42, s79, v42
    v_cvt_pk_bf16_f32 v144, v148, v149
    v_cvt_pk_bf16_f32 v145, v150, v151
    v_cvt_pk_bf16_f32 v146, v80, v81
    v_cvt_pk_bf16_f32 v147, v82, v83
    ds_write_b128 v12, v[144:147] offset:32768
    v_mfma_f32_16x16x32_bf16 v[172:175], v[70:73], v[168:171], v[44:47]
    v_mfma_f32_16x16x32_bf16 v[92:95], v[68:71], v[168:171], v[44:47]
    v_sqrt_f32 v42, v42
    s_nop 0
    v_cvt_pk_bf16_f32 v152, v156, v157
    v_cvt_pk_bf16_f32 v153, v158, v159
    v_cvt_pk_bf16_f32 v154, v84, v85
    v_cvt_pk_bf16_f32 v155, v86, v87
    ds_write_b128 v12, v[152:155] offset:40960
    v_mfma_f32_16x16x32_bf16 v[180:183], v[70:73], v[176:179], v[44:47]
    v_mfma_f32_16x16x32_bf16 v[80:83], v[68:71], v[176:179], v[44:47]
    v_cvt_pk_bf16_f32 v42, v42, v42
    v_cvt_pk_bf16_f32 v160, v164, v165
    v_cvt_pk_bf16_f32 v161, v166, v167
    v_cvt_pk_bf16_f32 v162, v88, v89
    v_cvt_pk_bf16_f32 v163, v90, v91
    ds_write_b128 v12, v[160:163] offset:49152
    v_mfma_f32_16x16x32_bf16 v[188:191], v[70:73], v[184:187], v[44:47]
    v_mfma_f32_16x16x32_bf16 v[84:87], v[68:71], v[184:187], v[44:47]
    v_and_b32 v42, s79, v42
    v_cvt_pk_bf16_f32 v168, v172, v173
    v_cvt_pk_bf16_f32 v169, v174, v175
    v_cvt_pk_bf16_f32 v170, v92, v93
    v_cvt_pk_bf16_f32 v171, v94, v95
    ds_write_b128 v12, v[168:171] offset:57344
    v_mfma_f32_16x16x32_bf16 v[196:199], v[70:73], v[192:195], v[44:47]
    v_mfma_f32_16x16x32_bf16 v[88:91], v[68:71], v[192:195], v[44:47]
    v_rcp_f32 v42, v42
    v_cvt_pk_bf16_f32 v176, v180, v181
    v_cvt_pk_bf16_f32 v177, v182, v183
    v_cvt_pk_bf16_f32 v178, v80, v81
    v_cvt_pk_bf16_f32 v179, v82, v83
    ds_write_b128 v18, v[176:179] offset:0
    v_mfma_f32_16x16x32_bf16 v[204:207], v[70:73], v[200:203], v[44:47]
    v_mfma_f32_16x16x32_bf16 v[92:95], v[68:71], v[200:203], v[44:47]
    s_nop 0
    v_cvt_pk_bf16_f32 v184, v188, v189
    v_cvt_pk_bf16_f32 v185, v190, v191
    v_cvt_pk_bf16_f32 v186, v84, v85
    v_cvt_pk_bf16_f32 v187, v86, v87
    ds_write_b128 v18, v[184:187] offset:8192
    v_mfma_f32_16x16x32_bf16 v[212:215], v[70:73], v[208:211], v[44:47]
    v_mfma_f32_16x16x32_bf16 v[80:83], v[68:71], v[208:211], v[44:47]
    v_mul_f32 v43, v41, v42
    v_mul_f32 v43, 0x3eeff558, v43
    v_cvt_pk_bf16_f32 v192, v196, v197
    v_cvt_pk_bf16_f32 v193, v198, v199
    v_cvt_pk_bf16_f32 v194, v88, v89
    v_cvt_pk_bf16_f32 v195, v90, v91
    ds_write_b128 v18, v[192:195] offset:16384
    v_mfma_f32_16x16x32_bf16 v[220:223], v[70:73], v[216:219], v[44:47]
    v_mfma_f32_16x16x32_bf16 v[84:87], v[68:71], v[216:219], v[44:47]
    v_lshlrev_b32 v42, 3, v17
    v_cvt_pk_bf16_f32 v200, v204, v205
    v_cvt_pk_bf16_f32 v201, v206, v207
    v_cvt_pk_bf16_f32 v202, v92, v93
    v_cvt_pk_bf16_f32 v203, v94, v95
    ds_write_b128 v18, v[200:203] offset:24576
    v_mfma_f32_16x16x32_bf16 v[228:231], v[70:73], v[224:227], v[44:47]
    v_mfma_f32_16x16x32_bf16 v[88:91], v[68:71], v[224:227], v[44:47]
    v_add_u32 v42, 157184, v42
    v_cvt_pk_bf16_f32 v208, v212, v213
    v_cvt_pk_bf16_f32 v209, v214, v215
    v_cvt_pk_bf16_f32 v210, v80, v81
    v_cvt_pk_bf16_f32 v211, v82, v83
    s_cmp_ge_u32 s93, 4
    s_cbranch_scc1 L_fd_done
    s_lshl_b32 s77, s4, 10
    s_cmp_eq_u32 s86, 1
    s_cbranch_scc1 L_fd_ssm
    s_mul_i32 s76, s5, 294912
    v_subrev_u32 v23, s76, v2
    v_min_u32 v62, 191, v0
    v_lshlrev_b32 v62, 2, v62
    v_add_u32 v62, s67, v62
    s_add_u32 m0, s77, 0
    s_add_u32 s74, s67, 0
    buffer_load_dwordx4 v23, s[12:15], s74 offen  lds
    s_add_u32 m0, s77, 4096
    s_add_u32 s74, s67, 294912
    buffer_load_dwordx4 v23, s[12:15], s74 offen  lds
    s_add_u32 m0, s77, 8192
    s_add_u32 s74, s67, 589824
    buffer_load_dwordx4 v23, s[12:15], s74 offen  lds
    s_add_u32 m0, s77, 12288
    s_add_u32 s74, s67, 884736
    buffer_load_dwordx4 v23, s[12:15], s74 offen  lds
    s_add_u32 m0, s77, 16384
    s_add_u32 s74, s67, 1179648
    buffer_load_dwordx4 v23, s[12:15], s74 offen  lds
    s_add_u32 m0, s77, 20480
    s_add_u32 s74, s67, 1474560
    buffer_load_dwordx4 v23, s[12:15], s74 offen  lds
    global_load_dword v31, v62, s[54:55]
    s_branch L_fd_done
L_fd_ssm:
    s_add_u32 m0, s77, 0
    s_add_u32 s74, s67, 0
    buffer_load_dwordx4 v2, s[12:15], s74 offen  lds
    s_add_u32 m0, s77, 4096
    s_add_u32 s74, s67, 18432
    buffer_load_dwordx4 v2, s[12:15], s74 offen  lds
    s_add_u32 m0, s77, 8192
    s_add_u32 s74, s67, 128
    buffer_load_dwordx4 v2, s[12:15], s74 offen  lds
    s_add_u32 m0, s77, 12288
    s_add_u32 s74, s67, 18560
    buffer_load_dwordx4 v2, s[12:15], s74 offen  lds
    s_add_u32 m0, s77, 16384
    s_add_u32 s74, s67, 256
    buffer_load_dwordx4 v2, s[12:15], s74 offen  lds
    s_add_u32 m0, s77, 20480
    s_add_u32 s74, s67, 18688
    buffer_load_dwordx4 v2, s[12:15], s74 offen  lds
L_fd_done:
    ds_write_b128 v18, v[208:211] offset:32768
    v_mfma_f32_16x16x32_bf16 v[236:239], v[70:73], v[232:235], v[44:47]
    v_mfma_f32_16x16x32_bf16 v[92:95], v[68:71], v[232:235], v[44:47]
    ds_write_b64 v42, v[40:41]
    v_cvt_pk_bf16_f32 v216, v220, v221
    v_cvt_pk_bf16_f32 v217, v222, v223
    v_cvt_pk_bf16_f32 v218, v84, v85
    v_cvt_pk_bf16_f32 v219, v86, v87
    ds_write_b128 v18, v[216:219] offset:40960
    v_mfma_f32_16x16x32_bf16 v[244:247], v[70:73], v[240:243], v[44:47]
    v_mfma_f32_16x16x32_bf16 v[80:83], v[68:71], v[240:243], v[44:47]
    v_lshlrev_b32 v42, 2, v17
    v_cvt_pk_bf16_f32 v224, v228, v229
    v_cvt_pk_bf16_f32 v225, v230, v231
    v_cvt_pk_bf16_f32 v226, v88, v89
    v_cvt_pk_bf16_f32 v227, v90, v91
    ds_write_b128 v18, v[224:227] offset:49152
    v_mfma_f32_16x16x32_bf16 v[252:255], v[70:73], v[248:251], v[44:47]
    v_mfma_f32_16x16x32_bf16 v[84:87], v[68:71], v[248:251], v[44:47]
    v_add_u32 v42, 158208, v42
    ds_write_b32 v42, v43
    v_cvt_pk_bf16_f32 v232, v236, v237
    v_cvt_pk_bf16_f32 v233, v238, v239
    v_cvt_pk_bf16_f32 v234, v92, v93
    v_cvt_pk_bf16_f32 v235, v94, v95
    ds_write_b128 v18, v[232:235] offset:57344
    v_cvt_pk_bf16_f32 v240, v244, v245
    v_cvt_pk_bf16_f32 v241, v246, v247
    v_cvt_pk_bf16_f32 v242, v80, v81
    v_cvt_pk_bf16_f32 v243, v82, v83
    s_nop 3
    v_cvt_pk_bf16_f32 v248, v252, v253
    v_cvt_pk_bf16_f32 v249, v254, v255
    v_cvt_pk_bf16_f32 v250, v84, v85
    v_cvt_pk_bf16_f32 v251, v86, v87
    s_cmp_eq_u32 s86, 1
    s_cbranch_scc1 L_pf_ssm
    s_cmp_ge_u32 s93, 4
    s_cbranch_scc1 L_pf_small
    s_cmp_lt_u32 s93, 2
    s_cbranch_scc1 L_pf_done
    s_mul_i32 s75, s87, 663552
    s_add_u32 s75, s75, s67
    v_add_u32 v61, -128, v0
    v_min_u32 v61, 215, v61
    v_mul_u32_u24 v62, 911, v61
    v_lshrrev_b32 v62, 16, v62
    v_mul_u32_u24 v62, 663424, v62
    v_mul_u32_u24 v23, 9216, v61
    v_sub_u32 v23, v23, v62
    buffer_load_dword v60, v23, s[12:15], s75 offen
    v_add_u32 v61, 0, v0
    v_min_u32 v61, 215, v61
    v_mul_u32_u24 v62, 911, v61
    v_lshrrev_b32 v62, 16, v62
    v_mul_u32_u24 v62, 663424, v62
    v_mul_u32_u24 v23, 9216, v61
    v_sub_u32 v23, v23, v62
    buffer_load_dword v60, v23, s[12:15], s75 offen
    s_branch L_pf_done
L_pf_ssm:
    s_cmp_ge_u32 s93, 4
    s_cbranch_scc1 L_pf_s2
    s_cmp_lt_u32 s93, 2
    s_cbranch_scc1 L_pf_done
    s_mul_i32 s75, s87, 9216
    s_add_u32 s75, s75, s67
    v_and_b32 v62, 127, v0
    v_min_u32 v62, 71, v62
    v_lshlrev_b32 v23, 7, v62
    v_add_u32 v23, s75, v23
    global_load_dword v60, v23, s[38:39]
    global_load_dword v60, v23, s[40:41]
    s_branch L_pf_done
L_pf_s2:
    global_load_ushort v3, v14, s[46:47]
    global_load_ushort v8, v14, s[34:35]
    global_load_ushort v9, v14, s[36:37]
    s_lshl_b32 s75, s6, 11
    s_mul_i32 s76, s81, 384
    s_add_u32 s76, s76, 31616
    v_mov_b32 v23, s75
    v_mov_b32 v18, s76
    v_cmp_gt_u32 vcc, 9, v1
    s_nop 1
    v_cndmask_b32 v18, v18, v23, vcc
    s_add_u32 s75, s75, 194560
    v_mov_b32 v23, s75
    v_cmp_le_u32 vcc, 16, v1
    s_nop 1
    v_cndmask_b32 v18, v18, v23, vcc
    v_lshl_add_u32 v18, v1, 7, v18
    s_mov_b32 s75, 41943040
    s_cmp_eq_u32 s93, 4
    s_cselect_b32 s75, s75, s22
    s_cmp_eq_u32 s6, 0
    s_cselect_b32 s76, 0xe00, 0
    s_cmp_eq_u32 s81, 0
    s_cselect_b32 s77, 0xffff01ff, 0
    s_or_b32 s76, s76, s77
    s_cbranch_scc0 L_fz_skip
    v_mov_b32 v23, 0
    s_mov_b32 exec_lo, s76
    s_mov_b32 exec_hi, 0
    buffer_store_dword v23, v18, s[20:23], s75 offen sc1
    s_mov_b64 exec, -1
L_fz_skip:
L_pf_small:
    s_cmp_lg_u32 s93, 4
    s_cbranch_scc1 L_pf_done
    v_min_u32 v62, 8, v1
    v_lshlrev_b32 v62, 7, v62
    global_load_dword v60, v62, s[48:49]
    global_load_dword v60, v62, s[58:59]
    v_mul_u32_u24 v62, 400, v62
    buffer_load_dword v60, v62, s[16:19], s85 offen
L_pf_done:
    s_cmp_eq_u32 s86, 1
    s_cbranch_scc1 L_ssm_main
    s_cmp_ge_u32 s93, 4
    s_cbranch_scc1 L_nobias
    s_cmp_ge_u32 s93, 2
    s_cbranch_scc1 L_bw1
    s_waitcnt vmcnt(0)
L_bw1:
    s_waitcnt vmcnt(2)
    v_lshlrev_b32 v24, 16, v31
    v_and_b32 v25, s79, v31
    v_mul_f32 v24, 0x3eeff558, v24
    v_mul_f32 v25, 0x3eeff558, v25
    v_min_u32 v23, 191, v0
    v_lshlrev_b32 v23, 3, v23
    v_add_u32 v23, 155648, v23
    ds_write_b64 v23, v[24:25]
L_nobias:
    s_waitcnt lgkmcnt(0)
    s_barrier
    s_mul_i32 s76, s5, 294912
    v_subrev_u32 v22, s76, v2
    s_lshl_b32 s50, s4, 10
    ds_read_b64_tr_b16 v[64:65], v4 offset:0
    ds_read_b128 v[112:115], v11 offset:0
    ds_read_b64_tr_b16 v[66:67], v4 offset:2048
    ds_read_b128 v[116:119], v11 offset:1024
    ds_read_b128 v[120:123], v11 offset:8192
    ds_read_b64_tr_b16 v[68:69], v5 offset:0
    ds_read_b128 v[124:127], v11 offset:9216
    ds_read_b64_tr_b16 v[70:71], v5 offset:2048
    ds_read_b128 v[128:131], v11 offset:16384
    ds_read_b128 v[132:135], v11 offset:17408
    ds_read_b64_tr_b16 v[72:73], v4 offset:4096
    ds_read_b64_tr_b16 v[74:75], v4 offset:6144
    ds_read_b64_tr_b16 v[76:77], v5 offset:4096
    ds_read_b128 v[136:139], v11 offset:24576
    ds_read_b64_tr_b16 v[78:79], v5 offset:6144
    ds_read_b64_tr_b16 v[80:81], v4 offset:8192
    ds_read_b128 v[140:143], v11 offset:25600
    s_waitcnt lgkmcnt(7)
    s_barrier
    s_cmp_lt_u32 s93, 4
    s_cbranch_scc1 L_hd2
    s_add_u32 m0, s50, 24576
    s_add_u32 s74, s67, 1769472
    buffer_load_dwordx4 v22, s[12:15], s74 offen  lds
    s_add_u32 m0, s50, 28672
    s_add_u32 s74, s67, 2064384
    buffer_load_dwordx4 v22, s[12:15], s74 offen  lds
    s_add_u32 m0, s50, 32768
    s_add_u32 s74, s67, 2359296
    buffer_load_dwordx4 v22, s[12:15], s74 offen  lds
    s_add_u32 m0, s50, 36864
    s_add_u32 s74, s67, 2654208
    buffer_load_dwordx4 v22, s[12:15], s74 offen  lds
    s_add_u32 m0, s50, 40960
    s_add_u32 s74, s67, 2949120
    buffer_load_dwordx4 v22, s[12:15], s74 offen  lds
    s_add_u32 m0, s50, 45056
    s_add_u32 s74, s67, 3244032
    buffer_load_dwordx4 v22, s[12:15], s74 offen  lds
L_hd2:
    v_mfma_f32_16x16x32_bf16 v[32:35], v[64:67], v[112:115], 0
    ds_read_b64_tr_b16 v[82:83], v4 offset:10240
    ds_read_b64_tr_b16 v[84:85], v5 offset:8192
    v_mfma_f32_16x16x32_bf16 v[40:43], v[64:67], v[116:119], 0
    ds_read_b64_tr_b16 v[86:87], v5 offset:10240
    ds_read_b128 v[144:147], v11 offset:32768
    v_mfma_f32_16x16x32_bf16 v[44:47], v[68:71], v[116:119], 0
    ds_read_b64_tr_b16 v[88:89], v4 offset:12288
    ds_read_b128 v[148:151], v11 offset:33792
    v_mfma_f32_16x16x32_bf16 v[36:39], v[68:71], v[112:115], 0
    ds_read_b64_tr_b16 v[90:91], v4 offset:14336
    ds_read_b128 v[152:155], v11 offset:40960
    s_waitcnt lgkmcnt(10)
    v_mfma_f32_16x16x32_bf16 v[32:35], v[72:75], v[120:123], v[32:35]
    ds_read_b64_tr_b16 v[92:93], v5 offset:12288
    ds_read_b64_tr_b16 v[94:95], v5 offset:14336
    v_mfma_f32_16x16x32_bf16 v[40:43], v[72:75], v[124:127], v[40:43]
    ds_read_b64_tr_b16 v[96:97], v4 offset:16384
    ds_read_b128 v[156:159], v11 offset:41984
    v_mfma_f32_16x16x32_bf16 v[44:47], v[76:79], v[124:127], v[44:47]
    ds_read_b64_tr_b16 v[98:99], v4 offset:18432
    v_mfma_f32_16x16x32_bf16 v[36:39], v[76:79], v[120:123], v[36:39]
    ds_read_b64_tr_b16 v[100:101], v5 offset:16384
    ds_read_b128 v[160:163], v11 offset:49152
    s_waitcnt lgkmcnt(12)
    v_mfma_f32_16x16x32_bf16 v[32:35], v[80:83], v[128:131], v[32:35]
    ds_read_b64_tr_b16 v[102:103], v5 offset:18432
    ds_read_b64_tr_b16 v[104:105], v4 offset:20480
    v_mfma_f32_16x16x32_bf16 v[40:43], v[80:83], v[132:135], v[40:43]
    ds_read_b64_tr_b16 v[106:107], v4 offset:22528
    ds_read_b128 v[164:167], v11 offset:50176
    v_mfma_f32_16x16x32_bf16 v[44:47], v[84:87], v[132:135], v[44:47]
    ds_read_b64_tr_b16 v[108:109], v5 offset:20480
    ds_read_b128 v[168:171], v11 offset:57344
    v_mfma_f32_16x16x32_bf16 v[36:39], v[84:87], v[128:131], v[36:39]
    ds_read_b64_tr_b16 v[110:111], v5 offset:22528
    ds_read_b128 v[172:175], v11 offset:58368
    s_waitcnt lgkmcnt(13)
    v_mfma_f32_16x16x32_bf16 v[32:35], v[88:91], v[136:139], v[32:35]
    v_mfma_f32_16x16x32_bf16 v[40:43], v[88:91], v[140:143], v[40:43]
    v_mfma_f32_16x16x32_bf16 v[44:47], v[92:95], v[140:143], v[44:47]
    v_mfma_f32_16x16x32_bf16 v[36:39], v[92:95], v[136:139], v[36:39]
    s_waitcnt vmcnt(0) lgkmcnt(0)
    s_barrier
    s_cmp_lt_u32 s93, 4
    s_cbranch_scc1 L_hd3
    s_setprio 1
    ds_write_b128 v12, v[240:243] offset:49152
    ds_write_b128 v12, v[248:251] offset:57344
    s_setprio 0
    s_add_u32 m0, s50, 49152
    s_add_u32 s74, s67, 3538944
    buffer_load_dwordx4 v22, s[12:15], s74 offen  lds
    s_add_u32 m0, s50, 53248
    s_add_u32 s74, s67, 3833856
    buffer_load_dwordx4 v22, s[12:15], s74 offen  lds
    s_add_u32 m0, s50, 57344
    s_add_u32 s74, s67, 4128768
    buffer_load_dwordx4 v22, s[12:15], s74 offen  lds
    s_add_u32 m0, s50, 61440
    s_add_u32 s74, s67, 4423680
    buffer_load_dwordx4 v22, s[12:15], s74 offen  lds
    s_add_u32 m0, s50, 65536
    s_add_u32 s74, s67, 4718592
    buffer_load_dwordx4 v22, s[12:15], s74 offen  lds
    s_add_u32 m0, s50, 69632
    s_add_u32 s74, s67, 5013504
    buffer_load_dwordx4 v22, s[12:15], s74 offen  lds
L_hd3:
    v_mfma_f32_16x16x32_bf16 v[32:35], v[96:99], v[144:147], v[32:35]
    ds_read_b64_tr_b16 v[64:65], v4 offset:24576
    v_mfma_f32_16x16x32_bf16 v[40:43], v[96:99], v[148:151], v[40:43]
    ds_read_b64_tr_b16 v[66:67], v4 offset:26624
    ds_read_b128 v[176:179], v19 offset:0
    v_mfma_f32_16x16x32_bf16 v[44:47], v[100:103], v[148:151], v[44:47]
    ds_read_b64_tr_b16 v[68:69], v5 offset:24576
    v_mfma_f32_16x16x32_bf16 v[36:39], v[100:103], v[144:147], v[36:39]
    ds_read_b64_tr_b16 v[70:71], v5 offset:26624
    ds_read_b128 v[180:183], v19 offset:1024
    v_mfma_f32_16x16x32_bf16 v[32:35], v[104:107], v[152:155], v[32:35]
    ds_read_b64_tr_b16 v[72:73], v4 offset:28672
    ds_read_b64_tr_b16 v[74:75], v4 offset:30720
    v_mfma_f32_16x16x32_bf16 v[40:43], v[104:107], v[156:159], v[40:43]
    ds_read_b64_tr_b16 v[76:77], v5 offset:28672
    ds_read_b128 v[184:187], v19 offset:8192
    v_mfma_f32_16x16x32_bf16 v[44:47], v[108:111], v[156:159], v[44:47]
    ds_read_b64_tr_b16 v[78:79], v5 offset:30720
    ds_read_b128 v[188:191], v19 offset:9216
    v_mfma_f32_16x16x32_bf16 v[36:39], v[108:111], v[152:155], v[36:39]
    ds_read_b64_tr_b16 v[80:81], v4 offset:32768
    ds_read_b128 v[192:195], v19 offset:16384
    s_waitcnt lgkmcnt(9)
    v_mfma_f32_16x16x32_bf16 v[32:35], v[64:67], v[160:163], v[32:35]
    ds_read_b64_tr_b16 v[82:83], v4 offset:34816
    ds_read_b64_tr_b16 v[84:85], v5 offset:32768
    v_mfma_f32_16x16x32_bf16 v[40:43], v[64:67], v[164:167], v[40:43]
    ds_read_b64_tr_b16 v[86:87], v5 offset:34816
    ds_read_b128 v[196:199], v19 offset:17408
    v_mfma_f32_16x16x32_bf16 v[44:47], v[68:71], v[164:167], v[44:47]
    ds_read_b64_tr_b16 v[88:89], v4 offset:36864
    v_mfma_f32_16x16x32_bf16 v[36:39], v[68:71], v[160:163], v[36:39]
    ds_read_b64_tr_b16 v[90:91], v4 offset:38912
    ds_read_b128 v[200:203], v19 offset:24576
    s_waitcnt lgkmcnt(10)
    v_mfma_f32_16x16x32_bf16 v[32:35], v[72:75], v[168:171], v[32:35]
    ds_read_b64_tr_b16 v[92:93], v5 offset:36864
    ds_read_b64_tr_b16 v[94:95], v5 offset:38912
    v_mfma_f32_16x16x32_bf16 v[40:43], v[72:75], v[172:175], v[40:43]
    ds_read_b64_tr_b16 v[96:97], v4 offset:40960
    ds_read_b128 v[204:207], v19 offset:25600
    v_mfma_f32_16x16x32_bf16 v[44:47], v[76:79], v[172:175], v[44:47]
    ds_read_b64_tr_b16 v[98:99], v4 offset:43008
    ds_read_b128 v[208:211], v19 offset:32768
    v_mfma_f32_16x16x32_bf16 v[36:39], v[76:79], v[168:171], v[36:39]
    ds_read_b64_tr_b16 v[100:101], v5 offset:40960
    ds_read_b128 v[212:215], v19 offset:33792
    s_waitcnt lgkmcnt(12)
    v_mfma_f32_16x16x32_bf16 v[32:35], v[80:83], v[176:179], v[32:35]
    ds_read_b64_tr_b16 v[102:103], v5 offset:43008
    ds_read_b64_tr_b16 v[104:105], v4 offset:45056
    v_mfma_f32_16x16x32_bf16 v[40:43], v[80:83], v[180:183], v[40:43]
    ds_read_b64_tr_b16 v[106:107], v4 offset:47104
    v_mfma_f32_16x16x32_bf16 v[44:47], v[84:87], v[180:183], v[44:47]
    ds_read_b64_tr_b16 v[108:109], v5 offset:45056
    v_mfma_f32_16x16x32_bf16 v[36:39], v[84:87], v[176:179], v[36:39]
    ds_read_b64_tr_b16 v[110:111], v5 offset:47104
    s_waitcnt lgkmcnt(11)
    v_mfma_f32_16x16x32_bf16 v[32:35], v[88:91], v[184:187], v[32:35]
    v_mfma_f32_16x16x32_bf16 v[40:43], v[88:91], v[188:191], v[40:43]
    v_mfma_f32_16x16x32_bf16 v[44:47], v[92:95], v[188:191], v[44:47]
    v_mfma_f32_16x16x32_bf16 v[36:39], v[92:95], v[184:187], v[36:39]
    s_cmp_ge_u32 s93, 4
    s_cbranch_scc1 L_hd4
    ds_write_b128 v12, v[240:243] offset:49152
    ds_write_b128 v12, v[248:251] offset:57344
    s_add_u32 m0, s50, 0
    s_add_u32 s74, s67, 128
    buffer_load_dwordx4 v22, s[12:15], s74 offen  lds
    s_add_u32 m0, s50, 4096
    s_add_u32 s74, s67, 295040
    buffer_load_dwordx4 v22, s[12:15], s74 offen  lds
    s_add_u32 m0, s50, 8192
    s_add_u32 s74, s67, 589952
    buffer_load_dwordx4 v22, s[12:15], s74 offen  lds
    s_add_u32 m0, s50, 12288
    s_add_u32 s74, s67, 884864
    buffer_load_dwordx4 v22, s[12:15], s74 offen  lds
    s_add_u32 m0, s50, 16384
    s_add_u32 s74, s67, 1179776
    buffer_load_dwordx4 v22, s[12:15], s74 offen  lds
    s_add_u32 m0, s50, 20480
    s_add_u32 s74, s67, 1474688
    buffer_load_dwordx4 v22, s[12:15], s74 offen  lds
L_hd4:
    s_cmp_lt_u32 s93, 4
    s_cbranch_scc1 L_b0w
    s_waitcnt vmcnt(0)
L_b0w:
    s_waitcnt lgkmcnt(0)
    s_barrier
    s_cmp_lt_u32 s93, 4
    s_cbranch_scc1 L_hd5
    s_add_u32 m0, s50, 24576
    s_add_u32 s74, s67, 1769600
    buffer_load_dwordx4 v22, s[12:15], s74 offen  lds
    s_add_u32 m0, s50, 28672
    s_add_u32 s74, s67, 2064512
    buffer_load_dwordx4 v22, s[12:15], s74 offen  lds
    s_add_u32 m0, s50, 32768
    s_add_u32 s74, s67, 2359424
    buffer_load_dwordx4 v22, s[12:15], s74 offen  lds
    s_add_u32 m0, s50, 36864
    s_add_u32 s74, s67, 2654336
    buffer_load_dwordx4 v22, s[12:15], s74 offen  lds
    s_add_u32 m0, s50, 40960
    s_add_u32 s74, s67, 2949248
    buffer_load_dwordx4 v22, s[12:15], s74 offen  lds
    s_add_u32 m0, s50, 45056
    s_add_u32 s74, s67, 3244160
    buffer_load_dwordx4 v22, s[12:15], s74 offen  lds
L_hd5:
    v_mfma_f32_16x16x32_bf16 v[32:35], v[96:99], v[192:195], v[32:35]
    ds_read_b64_tr_b16 v[64:65], v6 offset:0
    v_mfma_f32_16x16x32_bf16 v[40:43], v[96:99], v[196:199], v[40:43]
    ds_read_b64_tr_b16 v[66:67], v6 offset:2048
    ds_read_b128 v[216:219], v19 offset:40960
    v_mfma_f32_16x16x32_bf16 v[44:47], v[100:103], v[196:199], v[44:47]
    ds_read_b64_tr_b16 v[68:69], v7 offset:0
    ds_read_b128 v[220:223], v19 offset:41984
    v_mfma_f32_16x16x32_bf16 v[36:39], v[100:103], v[192:195], v[36:39]
    ds_read_b64_tr_b16 v[70:71], v7 offset:2048
    ds_read_b128 v[224:227], v19 offset:49152
    v_mfma_f32_16x16x32_bf16 v[32:35], v[104:107], v[200:203], v[32:35]
    ds_read_b64_tr_b16 v[72:73], v6 offset:4096
    ds_read_b64_tr_b16 v[74:75], v6 offset:6144
    v_mfma_f32_16x16x32_bf16 v[40:43], v[104:107], v[204:207], v[40:43]
    ds_read_b64_tr_b16 v[76:77], v7 offset:4096
    ds_read_b128 v[228:231], v19 offset:50176
    v_mfma_f32_16x16x32_bf16 v[44:47], v[108:111], v[204:207], v[44:47]
    ds_read_b64_tr_b16 v[78:79], v7 offset:6144
    ds_read_b128 v[232:235], v19 offset:57344
    v_mfma_f32_16x16x32_bf16 v[36:39], v[108:111], v[200:203], v[36:39]
    ds_read_b64_tr_b16 v[80:81], v6 offset:8192
    ds_read_b128 v[236:239], v19 offset:58368
    s_waitcnt lgkmcnt(9)
    v_mfma_f32_16x16x32_bf16 v[32:35], v[64:67], v[208:211], v[32:35]
    ds_read_b64_tr_b16 v[82:83], v6 offset:10240
    ds_read_b64_tr_b16 v[84:85], v7 offset:8192
    ds_read_b128 v[240:243], v11 offset:49152
    v_mfma_f32_16x16x32_bf16 v[40:43], v[64:67], v[212:215], v[40:43]
    ds_read_b64_tr_b16 v[86:87], v7 offset:10240
    ds_read_b128 v[244:247], v11 offset:50176
    v_mfma_f32_16x16x32_bf16 v[44:47], v[68:71], v[212:215], v[44:47]
    ds_read_b64_tr_b16 v[88:89], v6 offset:12288
    ds_read_b128 v[248:251], v11 offset:57344
    v_mfma_f32_16x16x32_bf16 v[36:39], v[68:71], v[208:211], v[36:39]
    ds_read_b64_tr_b16 v[90:91], v6 offset:14336
    ds_read_b128 v[252:255], v11 offset:58368
    s_waitcnt lgkmcnt(12)
    v_mfma_f32_16x16x32_bf16 v[32:35], v[72:75], v[216:219], v[32:35]
    ds_read_b64_tr_b16 v[92:93], v7 offset:12288
    ds_read_b64_tr_b16 v[94:95], v7 offset:14336
    v_mfma_f32_16x16x32_bf16 v[40:43], v[72:75], v[220:223], v[40:43]
    ds_read_b64_tr_b16 v[96:97], v6 offset:16384
    v_mfma_f32_16x16x32_bf16 v[44:47], v[76:79], v[220:223], v[44:47]
    ds_read_b64_tr_b16 v[98:99], v6 offset:18432
    v_mfma_f32_16x16x32_bf16 v[36:39], v[76:79], v[216:219], v[36:39]
    ds_read_b64_tr_b16 v[100:101], v7 offset:16384
    s_waitcnt lgkmcnt(10)
    v_mfma_f32_16x16x32_bf16 v[32:35], v[80:83], v[224:227], v[32:35]
    ds_read_b64_tr_b16 v[102:103], v7 offset:18432
    ds_read_b64_tr_b16 v[104:105], v6 offset:20480
    v_mfma_f32_16x16x32_bf16 v[40:43], v[80:83], v[228:231], v[40:43]
    ds_read_b64_tr_b16 v[106:107], v6 offset:22528
    v_mfma_f32_16x16x32_bf16 v[44:47], v[84:87], v[228:231], v[44:47]
    ds_read_b64_tr_b16 v[108:109], v7 offset:20480
    v_mfma_f32_16x16x32_bf16 v[36:39], v[84:87], v[224:227], v[36:39]
    ds_read_b64_tr_b16 v[110:111], v7 offset:22528
    v_and_b32 v23, 15, v1
    s_lshl_b32 s75, s4, 7
    s_add_u32 s75, s75, 158208
    v_lshlrev_b32 v23, 2, v23
    v_add_u32 v23, s75, v23
    ds_read2_b32 v[10:11], v23 offset0:0 offset1:16
    s_waitcnt lgkmcnt(9)
    v_mfma_f32_16x16x32_bf16 v[32:35], v[88:91], v[232:235], v[32:35]
    v_mfma_f32_16x16x32_bf16 v[40:43], v[88:91], v[236:239], v[40:43]
    v_mfma_f32_16x16x32_bf16 v[44:47], v[92:95], v[236:239], v[44:47]
    v_mfma_f32_16x16x32_bf16 v[36:39], v[92:95], v[232:235], v[36:39]
    s_cmp_ge_u32 s93, 4
    s_cbranch_scc1 L_b0w2
    s_waitcnt vmcnt(0)
L_b0w2:
    s_mov_b32 s78, 5
    v_mul_u32_u24 v12, s99, v1
    s_cmp_lt_u32 s93, 4
    s_cbranch_scc1 L_nt6o
L_nt6:
    s_mov_b64 vcc, 0
    s_waitcnt lgkmcnt(0)
    s_branch L_p1
L_nt6o:
    s_cmp_eq_u32 s78, 1
    s_cbranch_scc1 L_nt6
    s_mov_b32 exec_hi, 65535
    buffer_load_dword v0, v12, s[36:39], s98 offen
    s_mov_b32 exec_hi, -1
    s_add_u32 s98, s98, s51
    s_branch L_nt6
L_p1_sw:
    s_mov_b32 s68, s16
    s_mov_b32 s69, s17
    s_mov_b32 s70, s18
    v_mov_b32 v14, v3
    s_mov_b32 s73, 73728
    s_mov_b32 s72, s85
    s_branch L_p1_nosw
L_nt7o:
    s_cmp_eq_u32 s78, 1
    s_cbranch_scc1 L_nt7
    s_mov_b32 exec_hi, 65535
    buffer_load_dword v0, v12, s[36:39], s98 offen
    s_mov_b32 exec_hi, -1
    s_add_u32 s98, s98, s51
    s_branch L_nt7
.p2align 3
L_p1:
    s_add_u32 s67, s67, 128
    s_add_u32 s72, s67, 128
    s_cmp_eq_u32 s78, 1
    s_cbranch_scc1 L_p1_sw
L_p1_nosw:
    s_waitcnt vmcnt(3) lgkmcnt(1)
    s_barrier
    v_mfma_f32_16x16x32_bf16 v[32:35], v[96:99], v[240:243], v[32:35]
    ds_read_b64_tr_b16 v[64:65], v4 offset:0
    ds_read_b128 v[24:27], v8
    v_mfma_f32_16x16x32_bf16 v[40:43], v[96:99], v[244:247], v[40:43]
    ds_read_b64_tr_b16 v[66:67], v4 offset:2048
    ds_read_b128 v[28:31], v8 offset:64
    v_mfma_f32_16x16x32_bf16 v[44:47], v[100:103], v[244:247], v[44:47]
    ds_read_b64_tr_b16 v[68:69], v5 offset:0
    v_add_u32 v8, 256, v8
    v_mfma_f32_16x16x32_bf16 v[36:39], v[100:103], v[240:243], v[36:39]
    ds_read_b64_tr_b16 v[70:71], v5 offset:2048
    s_add_u32 m0, s66, 49152
    s_add_u32 s74, s67, 3538944
    buffer_load_dwordx4 v2, s[12:15], s74 offen  lds
    v_mfma_f32_16x16x32_bf16 v[48:51], v[104:107], v[248:251], v[32:35]
    ds_read_b64_tr_b16 v[72:73], v4 offset:4096
    ds_read_b64_tr_b16 v[74:75], v4 offset:6144
    v_mfma_f32_16x16x32_bf16 v[56:59], v[104:107], v[252:255], v[40:43]
    ds_read_b64_tr_b16 v[76:77], v5 offset:4096
    v_mfma_f32_16x16x32_bf16 v[60:63], v[108:111], v[252:255], v[44:47]
    ds_read_b64_tr_b16 v[78:79], v5 offset:6144
    v_mfma_f32_16x16x32_bf16 v[52:55], v[108:111], v[248:251], v[36:39]
    ds_read_b64_tr_b16 v[80:81], v4 offset:8192
    s_add_u32 m0, s66, 57344
    s_add_u32 s74, s67, 4128768
    buffer_load_dwordx4 v2, s[12:15], s74 offen  lds
    s_waitcnt lgkmcnt(5)
    v_mfma_f32_16x16x32_bf16 v[32:35], v[64:67], v[112:115], 0
    ds_read_b64_tr_b16 v[82:83], v4 offset:10240
    ds_read_b64_tr_b16 v[84:85], v5 offset:8192
    v_mfma_f32_16x16x32_bf16 v[40:43], v[64:67], v[116:119], 0
    ds_read_b64_tr_b16 v[86:87], v5 offset:10240
    v_mfma_f32_16x16x32_bf16 v[44:47], v[68:71], v[116:119], 0
    ds_read_b64_tr_b16 v[88:89], v4 offset:12288
    v_mfma_f32_16x16x32_bf16 v[36:39], v[68:71], v[112:115], 0
    ds_read_b64_tr_b16 v[90:91], v4 offset:14336
    s_add_u32 m0, s66, 65536
    s_add_u32 s74, s67, 4718592
    buffer_load_dwordx4 v2, s[12:15], s74 offen  lds
    s_waitcnt lgkmcnt(6)
    v_mfma_f32_16x16x32_bf16 v[32:35], v[72:75], v[120:123], v[32:35]
    ds_read_b64_tr_b16 v[92:93], v5 offset:12288
    ds_read_b64_tr_b16 v[94:95], v5 offset:14336
    v_fma_f32 v48, v48, v10, v24
    v_fma_f32 v49, v49, v10, v25
    v_fma_f32 v50, v50, v10, v26
    v_mfma_f32_16x16x32_bf16 v[40:43], v[72:75], v[124:127], v[40:43]
    ds_read_b64_tr_b16 v[96:97], v4 offset:16384
    v_fma_f32 v51, v51, v10, v27
    v_fma_f32 v16, -v48, v48, s80
    v_fma_f32 v17, -v49, v49, s80
    v_mfma_f32_16x16x32_bf16 v[44:47], v[76:79], v[124:127], v[44:47]
    ds_read_b64_tr_b16 v[98:99], v4 offset:18432
    v_fma_f32 v18, -v50, v50, s80
    v_fma_f32 v19, -v51, v51, s80
    v_mul_f32 v16, v48, v16
    v_mfma_f32_16x16x32_bf16 v[36:39], v[76:79], v[120:123], v[36:39]
    ds_read_b64_tr_b16 v[100:101], v5 offset:16384
    v_mul_f32 v17, v49, v17
    v_mul_f32 v18, v50, v18
    v_mul_f32 v19, v51, v19
    v_exp_f32 v16, v16
    s_waitcnt lgkmcnt(7)
    v_mfma_f32_16x16x32_bf16 v[32:35], v[80:83], v[128:131], v[32:35]
    ds_read_b64_tr_b16 v[102:103], v5 offset:18432
    ds_read_b64_tr_b16 v[104:105], v4 offset:20480
    v_exp_f32 v17, v17
    v_exp_f32 v18, v18
    v_exp_f32 v19, v19
    v_mfma_f32_16x16x32_bf16 v[40:43], v[80:83], v[132:135], v[40:43]
    ds_read_b64_tr_b16 v[106:107], v4 offset:22528
    v_add_f32 v16, 1.0, v16
    v_add_f32 v17, 1.0, v17
    v_add_f32 v18, 1.0, v18
    v_mfma_f32_16x16x32_bf16 v[44:47], v[84:87], v[132:135], v[44:47]
    ds_read_b64_tr_b16 v[108:109], v5 offset:20480
    v_add_f32 v19, 1.0, v19
    v_rcp_f32 v16, v16
    v_rcp_f32 v17, v17
    v_mfma_f32_16x16x32_bf16 v[36:39], v[84:87], v[128:131], v[36:39]
    ds_read_b64_tr_b16 v[110:111], v5 offset:22528
    v_rcp_f32 v18, v18
    v_rcp_f32 v19, v19
    v_mul_f32 v16, v48, v16
    v_mul_f32 v17, v49, v17
    s_waitcnt lgkmcnt(8)
    v_mfma_f32_16x16x32_bf16 v[32:35], v[88:91], v[136:139], v[32:35]
    v_mul_f32 v18, v50, v18
    v_mul_f32 v19, v51, v19
    v_cvt_pk_bf16_f32 v48, v16, v17
    v_mfma_f32_16x16x32_bf16 v[40:43], v[88:91], v[140:143], v[40:43]
    v_cvt_pk_bf16_f32 v49, v18, v19
    v_fma_f32 v52, v52, v10, v28
    v_fma_f32 v53, v53, v10, v29
    v_fma_f32 v54, v54, v10, v30
    v_mfma_f32_16x16x32_bf16 v[44:47], v[92:95], v[140:143], v[44:47]
    v_fma_f32 v55, v55, v10, v31
    v_fma_f32 v20, -v52, v52, s80
    v_fma_f32 v21, -v53, v53, s80
    v_mfma_f32_16x16x32_bf16 v[36:39], v[92:95], v[136:139], v[36:39]
    v_fma_f32 v22, -v54, v54, s80
    v_fma_f32 v23, -v55, v55, s80
    v_mul_f32 v20, v52, v20
    v_mul_f32 v21, v53, v21
    s_waitcnt vmcnt(3) lgkmcnt(0)
    s_barrier
    v_mfma_f32_16x16x32_bf16 v[32:35], v[96:99], v[144:147], v[32:35]
    ds_read_b64_tr_b16 v[64:65], v4 offset:24576
    v_mul_f32 v22, v54, v22
    v_mfma_f32_16x16x32_bf16 v[40:43], v[96:99], v[148:151], v[40:43]
    ds_read_b64_tr_b16 v[66:67], v4 offset:26624
    v_mul_f32 v23, v55, v23
    v_exp_f32 v20, v20
    v_mfma_f32_16x16x32_bf16 v[44:47], v[100:103], v[148:151], v[44:47]
    ds_read_b64_tr_b16 v[68:69], v5 offset:24576
    v_exp_f32 v21, v21
    v_exp_f32 v22, v22
    v_mfma_f32_16x16x32_bf16 v[36:39], v[100:103], v[144:147], v[36:39]
    ds_read_b64_tr_b16 v[70:71], v5 offset:26624
    v_exp_f32 v23, v23
    s_add_u32 m0, s66, 0
    s_nop 0
    buffer_load_dwordx4 v14, s[68:71], s72 offen  lds
    s_add_u32 s72, s72, s73
    v_mfma_f32_16x16x32_bf16 v[32:35], v[104:107], v[152:155], v[32:35]
    ds_read_b64_tr_b16 v[72:73], v4 offset:28672
    ds_read_b64_tr_b16 v[74:75], v4 offset:30720
    v_add_f32 v20, 1.0, v20
    v_add_f32 v21, 1.0, v21
    v_mfma_f32_16x16x32_bf16 v[40:43], v[104:107], v[156:159], v[40:43]
    ds_read_b64_tr_b16 v[76:77], v5 offset:28672
    v_add_f32 v22, 1.0, v22
    v_add_f32 v23, 1.0, v23
    v_mfma_f32_16x16x32_bf16 v[44:47], v[108:111], v[156:159], v[44:47]
    ds_read_b64_tr_b16 v[78:79], v5 offset:30720
    v_rcp_f32 v20, v20
    v_rcp_f32 v21, v21
    v_mfma_f32_16x16x32_bf16 v[36:39], v[108:111], v[152:155], v[36:39]
    ds_read_b64_tr_b16 v[80:81], v4 offset:32768
    v_rcp_f32 v22, v22
    s_add_u32 m0, s66, 8192
    s_nop 0
    buffer_load_dwordx4 v14, s[68:71], s72 offen  lds
    s_add_u32 s72, s72, s73
    s_waitcnt lgkmcnt(5)
    v_mfma_f32_16x16x32_bf16 v[32:35], v[64:67], v[160:163], v[32:35]
    ds_read_b64_tr_b16 v[82:83], v4 offset:34816
    ds_read_b64_tr_b16 v[84:85], v5 offset:32768
    v_rcp_f32 v23, v23
    v_mul_f32 v20, v52, v20
    v_mfma_f32_16x16x32_bf16 v[40:43], v[64:67], v[164:167], v[40:43]
    ds_read_b64_tr_b16 v[86:87], v5 offset:34816
    v_mul_f32 v21, v53, v21
    v_mul_f32 v22, v54, v22
    v_mfma_f32_16x16x32_bf16 v[44:47], v[68:71], v[164:167], v[44:47]
    ds_read_b64_tr_b16 v[88:89], v4 offset:36864
    v_mul_f32 v23, v55, v23
    v_cvt_pk_bf16_f32 v50, v20, v21
    v_mfma_f32_16x16x32_bf16 v[36:39], v[68:71], v[160:163], v[36:39]
    ds_read_b64_tr_b16 v[90:91], v4 offset:38912
    v_cvt_pk_bf16_f32 v51, v22, v23
    s_add_u32 m0, s66, 16384
    s_nop 0
    buffer_load_dwordx4 v14, s[68:71], s72 offen  lds
    s_add_u32 s72, s72, s73
    s_waitcnt lgkmcnt(6)
    v_mfma_f32_16x16x32_bf16 v[32:35], v[72:75], v[168:171], v[32:35]
    ds_read_b64_tr_b16 v[92:93], v5 offset:36864
    ds_read_b64_tr_b16 v[94:95], v5 offset:38912
    v_fma_f32 v56, v56, v11, v24
    v_mfma_f32_16x16x32_bf16 v[40:43], v[72:75], v[172:175], v[40:43]
    ds_read_b64_tr_b16 v[96:97], v4 offset:40960
    v_fma_f32 v57, v57, v11, v25
    v_fma_f32 v58, v58, v11, v26
    v_mfma_f32_16x16x32_bf16 v[44:47], v[76:79], v[172:175], v[44:47]
    ds_read_b64_tr_b16 v[98:99], v4 offset:43008
    v_fma_f32 v59, v59, v11, v27
    v_mfma_f32_16x16x32_bf16 v[36:39], v[76:79], v[168:171], v[36:39]
    ds_read_b64_tr_b16 v[100:101], v5 offset:40960
    v_fma_f32 v16, -v56, v56, s80
    v_fma_f32 v17, -v57, v57, s80
    s_waitcnt lgkmcnt(7)
    v_mfma_f32_16x16x32_bf16 v[32:35], v[80:83], v[176:179], v[32:35]
    ds_read_b64_tr_b16 v[102:103], v5 offset:43008
    ds_read_b64_tr_b16 v[104:105], v4 offset:45056
    v_fma_f32 v18, -v58, v58, s80
    v_mfma_f32_16x16x32_bf16 v[40:43], v[80:83], v[180:183], v[40:43]
    ds_read_b64_tr_b16 v[106:107], v4 offset:47104
    v_fma_f32 v19, -v59, v59, s80
    v_mul_f32 v16, v56, v16
    v_mfma_f32_16x16x32_bf16 v[44:47], v[84:87], v[180:183], v[44:47]
    ds_read_b64_tr_b16 v[108:109], v5 offset:45056
    v_mul_f32 v17, v57, v17
    v_mul_f32 v18, v58, v18
    v_mfma_f32_16x16x32_bf16 v[36:39], v[84:87], v[176:179], v[36:39]
    ds_read_b64_tr_b16 v[110:111], v5 offset:47104
    v_mul_f32 v19, v59, v19
    v_exp_f32 v16, v16
    s_waitcnt lgkmcnt(8)
    v_mfma_f32_16x16x32_bf16 v[32:35], v[88:91], v[184:187], v[32:35]
    ds_write_b128 v9, v[48:51] offset:0
    v_mfma_f32_16x16x32_bf16 v[40:43], v[88:91], v[188:191], v[40:43]
    v_exp_f32 v17, v17
    v_exp_f32 v18, v18
    v_mfma_f32_16x16x32_bf16 v[44:47], v[92:95], v[188:191], v[44:47]
    v_exp_f32 v19, v19
    v_add_f32 v16, 1.0, v16
    v_mfma_f32_16x16x32_bf16 v[36:39], v[92:95], v[184:187], v[36:39]
    v_add_f32 v17, 1.0, v17
    v_add_f32 v18, 1.0, v18
    v_add_f32 v19, 1.0, v19
    s_waitcnt vmcnt(3) lgkmcnt(1)
    s_barrier
    v_mfma_f32_16x16x32_bf16 v[32:35], v[96:99], v[192:195], v[32:35]
    ds_read_b64_tr_b16 v[64:65], v6 offset:0
    v_rcp_f32 v16, v16
    v_rcp_f32 v17, v17
    v_mfma_f32_16x16x32_bf16 v[40:43], v[96:99], v[196:199], v[40:43]
    ds_read_b64_tr_b16 v[66:67], v6 offset:2048
    v_rcp_f32 v18, v18
    v_rcp_f32 v19, v19
    v_mfma_f32_16x16x32_bf16 v[44:47], v[100:103], v[196:199], v[44:47]
    ds_read_b64_tr_b16 v[68:69], v7 offset:0
    v_mul_f32 v16, v56, v16
    v_mul_f32 v17, v57, v17
    v_mfma_f32_16x16x32_bf16 v[36:39], v[100:103], v[192:195], v[36:39]
    ds_read_b64_tr_b16 v[70:71], v7 offset:2048
    v_mul_f32 v18, v58, v18
    v_mul_f32 v19, v59, v19
    s_add_u32 m0, s66, 24576
    s_nop 0
    buffer_load_dwordx4 v14, s[68:71], s72 offen  lds
    s_add_u32 s72, s72, s73
    v_mfma_f32_16x16x32_bf16 v[32:35], v[104:107], v[200:203], v[32:35]
    ds_read_b64_tr_b16 v[72:73], v6 offset:4096
    ds_read_b64_tr_b16 v[74:75], v6 offset:6144
    v_cvt_pk_bf16_f32 v56, v16, v17
    v_cvt_pk_bf16_f32 v57, v18, v19
    v_mfma_f32_16x16x32_bf16 v[40:43], v[104:107], v[204:207], v[40:43]
    ds_read_b64_tr_b16 v[76:77], v7 offset:4096
    v_fma_f32 v60, v60, v11, v28
    v_fma_f32 v61, v61, v11, v29
    v_mfma_f32_16x16x32_bf16 v[44:47], v[108:111], v[204:207], v[44:47]
    ds_read_b64_tr_b16 v[78:79], v7 offset:6144
    v_fma_f32 v62, v62, v11, v30
    v_fma_f32 v63, v63, v11, v31
    v_mfma_f32_16x16x32_bf16 v[36:39], v[108:111], v[200:203], v[36:39]
    ds_read_b64_tr_b16 v[80:81], v6 offset:8192
    v_fma_f32 v20, -v60, v60, s80
    v_fma_f32 v21, -v61, v61, s80
    s_add_u32 m0, s66, 32768
    s_nop 0
    buffer_load_dwordx4 v14, s[68:71], s72 offen  lds
    s_add_u32 s72, s72, s73
    s_waitcnt lgkmcnt(5)
    v_mfma_f32_16x16x32_bf16 v[32:35], v[64:67], v[208:211], v[32:35]
    ds_read_b64_tr_b16 v[82:83], v6 offset:10240
    ds_read_b64_tr_b16 v[84:85], v7 offset:8192
    v_fma_f32 v22, -v62, v62, s80
    v_fma_f32 v23, -v63, v63, s80
    v_mfma_f32_16x16x32_bf16 v[40:43], v[64:67], v[212:215], v[40:43]
    ds_read_b64_tr_b16 v[86:87], v7 offset:10240
    v_mul_f32 v20, v60, v20
    v_mul_f32 v21, v61, v21
    v_mfma_f32_16x16x32_bf16 v[44:47], v[68:71], v[212:215], v[44:47]
    ds_read_b64_tr_b16 v[88:89], v6 offset:12288
    v_mul_f32 v22, v62, v22
    v_mul_f32 v23, v63, v23
    v_mfma_f32_16x16x32_bf16 v[36:39], v[68:71], v[208:211], v[36:39]
    ds_read_b64_tr_b16 v[90:91], v6 offset:14336
    v_exp_f32 v20, v20
    v_exp_f32 v21, v21
    s_add_u32 m0, s66, 40960
    s_nop 0
    buffer_load_dwordx4 v14, s[68:71], s72 offen  lds
    s_add_u32 s72, s72, s73
    s_waitcnt lgkmcnt(6)
    v_mfma_f32_16x16x32_bf16 v[32:35], v[72:75], v[216:219], v[32:35]
    ds_read_b64_tr_b16 v[92:93], v7 offset:12288
    ds_read_b64_tr_b16 v[94:95], v7 offset:14336
    v_exp_f32 v22, v22
    v_exp_f32 v23, v23
    v_mfma_f32_16x16x32_bf16 v[40:43], v[72:75], v[220:223], v[40:43]
    ds_read_b64_tr_b16 v[96:97], v6 offset:16384
    v_add_f32 v20, 1.0, v20
    v_add_f32 v21, 1.0, v21
    v_mfma_f32_16x16x32_bf16 v[44:47], v[76:79], v[220:223], v[44:47]
    ds_read_b64_tr_b16 v[98:99], v6 offset:18432
    v_add_f32 v22, 1.0, v22
    v_add_f32 v23, 1.0, v23
    v_mfma_f32_16x16x32_bf16 v[36:39], v[76:79], v[216:219], v[36:39]
    ds_read_b64_tr_b16 v[100:101], v7 offset:16384
    v_rcp_f32 v20, v20
    v_rcp_f32 v21, v21
    s_waitcnt lgkmcnt(7)
    v_mfma_f32_16x16x32_bf16 v[32:35], v[80:83], v[224:227], v[32:35]
    ds_read_b64_tr_b16 v[102:103], v7 offset:18432
    ds_read_b64_tr_b16 v[104:105], v6 offset:20480
    v_rcp_f32 v22, v22
    v_rcp_f32 v23, v23
    v_mfma_f32_16x16x32_bf16 v[40:43], v[80:83], v[228:231], v[40:43]
    ds_read_b64_tr_b16 v[106:107], v6 offset:22528
    v_mul_f32 v20, v60, v20
    v_mul_f32 v21, v61, v21
    v_mfma_f32_16x16x32_bf16 v[44:47], v[84:87], v[228:231], v[44:47]
    ds_read_b64_tr_b16 v[108:109], v7 offset:20480
    v_mul_f32 v22, v62, v22
    v_mul_f32 v23, v63, v23
    v_mfma_f32_16x16x32_bf16 v[36:39], v[84:87], v[224:227], v[36:39]
    ds_read_b64_tr_b16 v[110:111], v7 offset:22528
    v_cvt_pk_bf16_f32 v58, v20, v21
    v_cvt_pk_bf16_f32 v59, v22, v23
    s_waitcnt lgkmcnt(8)
    v_mfma_f32_16x16x32_bf16 v[32:35], v[88:91], v[232:235], v[32:35]
    v_mfma_f32_16x16x32_bf16 v[40:43], v[88:91], v[236:239], v[40:43]
    ds_write_b128 v9, v[56:59] offset:1024
    v_mfma_f32_16x16x32_bf16 v[44:47], v[92:95], v[236:239], v[44:47]
    v_add_u32 v9, 16384, v9
    v_mfma_f32_16x16x32_bf16 v[36:39], v[92:95], v[232:235], v[36:39]
    s_cmp_lt_u32 s93, 4
    s_cbranch_scc1 L_nt7o
L_nt7:
    s_sub_u32 s78, s78, 1
    s_cmp_lg_u32 s78, 0
    s_cbranch_scc1 L_p1
    s_lshl_b32 s76, s4, 11
    s_add_u32 s76, s76, 73728
    v_lshlrev_b32 v2, 4, v1
    v_add_u32 v2, s76, v2
    v_add_u32 v14, 40960, v2
    v_subrev_u32 v9, 155648, v9
    s_waitcnt vmcnt(0) lgkmcnt(0)
    s_barrier
    s_cmp_lg_u32 s93, 0
    s_cbranch_scc1 L_cii8
    s_lshl_b32 s76, s6, 4
    buffer_load_ubyte v12, off, s[28:31], s76 offset:0 sc1
L_cii8:
    v_mfma_f32_16x16x32_bf16 v[32:35], v[96:99], v[240:243], v[32:35]
    ds_read_b64_tr_b16 v[64:65], v4 offset:0
    s_add_u32 s85, s85, 128
    ds_read_b128 v[24:27], v8
    v_mfma_f32_16x16x32_bf16 v[40:43], v[96:99], v[244:247], v[40:43]
    ds_read_b64_tr_b16 v[66:67], v4 offset:2048
    ds_read_b128 v[28:31], v8 offset:64
    ds_read_b128 v[160:163], v2 offset:0
    v_mfma_f32_16x16x32_bf16 v[44:47], v[100:103], v[244:247], v[44:47]
    ds_read_b64_tr_b16 v[68:69], v5 offset:0
    ds_read_b128 v[164:167], v2 offset:1024
    ds_read_b128 v[168:171], v2 offset:8192
    v_mfma_f32_16x16x32_bf16 v[36:39], v[100:103], v[240:243], v[36:39]
    ds_read_b64_tr_b16 v[70:71], v5 offset:2048
    ds_read_b128 v[172:175], v2 offset:9216
    ds_read_b128 v[176:179], v2 offset:16384
    s_add_u32 m0, s66, 49152
    s_add_u32 s74, s85, 0
    buffer_load_dwordx4 v3, s[16:19], s74 offen  lds
    v_mfma_f32_16x16x32_bf16 v[48:51], v[104:107], v[248:251], v[32:35]
    ds_read_b64_tr_b16 v[72:73], v4 offset:4096
    ds_read_b128 v[180:183], v2 offset:17408
    v_mfma_f32_16x16x32_bf16 v[56:59], v[104:107], v[252:255], v[40:43]
    ds_read_b64_tr_b16 v[74:75], v4 offset:6144
    ds_read_b128 v[184:187], v2 offset:24576
    ds_read_b128 v[188:191], v2 offset:25600
    v_mfma_f32_16x16x32_bf16 v[60:63], v[108:111], v[252:255], v[44:47]
    ds_read_b64_tr_b16 v[76:77], v5 offset:4096
    ds_read_b128 v[192:195], v2 offset:32768
    v_mfma_f32_16x16x32_bf16 v[52:55], v[108:111], v[248:251], v[36:39]
    ds_read_b64_tr_b16 v[78:79], v5 offset:6144
    ds_read_b128 v[196:199], v2 offset:33792
    s_add_u32 m0, s66, 57344
    s_add_u32 s74, s85, 73728
    buffer_load_dwordx4 v3, s[16:19], s74 offen  lds
    s_waitcnt lgkmcnt(11)
    v_mfma_f32_16x16x32_bf16 v[32:35], v[64:67], v[160:163], 0
    ds_read_b64_tr_b16 v[80:81], v4 offset:8192
    ds_read_b128 v[200:203], v14 offset:0
    ds_read_b128 v[204:207], v14 offset:1024
    ds_read_b128 v[208:211], v14 offset:8192
    ds_read_b128 v[212:215], v14 offset:9216
    v_mfma_f32_16x16x32_bf16 v[40:43], v[64:67], v[164:167], 0
    ds_read_b64_tr_b16 v[82:83], v4 offset:10240
    ds_read_b128 v[216:219], v14 offset:16384
    v_fma_f32 v48, v48, v10, v24
    v_fma_f32 v49, v49, v10, v25
    v_fma_f32 v50, v50, v10, v26
    v_fma_f32 v51, v51, v10, v27
    v_mfma_f32_16x16x32_bf16 v[44:47], v[68:71], v[164:167], 0
    ds_read_b64_tr_b16 v[84:85], v5 offset:8192
    v_fma_f32 v16, -v48, v48, s80
    v_fma_f32 v17, -v49, v49, s80
    v_fma_f32 v18, -v50, v50, s80
    v_fma_f32 v19, -v51, v51, s80
    v_mul_f32 v16, v48, v16
    v_mfma_f32_16x16x32_bf16 v[36:39], v[68:71], v[160:163], 0
    ds_read_b64_tr_b16 v[86:87], v5 offset:10240
    v_mul_f32 v17, v49, v17
    v_mul_f32 v18, v50, v18
    v_mul_f32 v19, v51, v19
    v_exp_f32 v16, v16
    s_add_u32 m0, s66, 65536
    s_add_u32 s74, s85, 147456
    buffer_load_dwordx4 v3, s[16:19], s74 offen  lds
    s_waitcnt lgkmcnt(10)
    v_mfma_f32_16x16x32_bf16 v[32:35], v[72:75], v[168:171], v[32:35]
    ds_read_b64_tr_b16 v[88:89], v4 offset:12288
    ds_read_b128 v[220:223], v14 offset:17408
    ds_read_b128 v[224:227], v14 offset:24576
    ds_read_b128 v[228:231], v14 offset:25600
    ds_read_b128 v[232:235], v14 offset:32768
    v_mfma_f32_16x16x32_bf16 v[40:43], v[72:75], v[172:175], v[40:43]
    ds_read_b64_tr_b16 v[90:91], v4 offset:14336
    ds_read_b128 v[236:239], v14 offset:33792
    v_exp_f32 v17, v17
    v_exp_f32 v18, v18
    v_exp_f32 v19, v19
    v_add_f32 v16, 1.0, v16
    v_mfma_f32_16x16x32_bf16 v[44:47], v[76:79], v[172:175], v[44:47]
    ds_read_b64_tr_b16 v[92:93], v5 offset:12288
    v_add_f32 v17, 1.0, v17
    v_add_f32 v18, 1.0, v18
    v_add_f32 v19, 1.0, v19
    v_rcp_f32 v16, v16
    v_mfma_f32_16x16x32_bf16 v[36:39], v[76:79], v[168:171], v[36:39]
    ds_read_b64_tr_b16 v[94:95], v5 offset:14336
    v_rcp_f32 v17, v17
    v_rcp_f32 v18, v18
    v_rcp_f32 v19, v19
    v_mul_f32 v16, v48, v16
    v_mul_f32 v17, v49, v17
    s_waitcnt lgkmcnt(9)
    v_mfma_f32_16x16x32_bf16 v[32:35], v[80:83], v[176:179], v[32:35]
    ds_read_b64_tr_b16 v[64:65], v4 offset:16384
    v_mul_f32 v18, v50, v18
    v_mul_f32 v19, v51, v19
    v_cvt_pk_bf16_f32 v48, v16, v17
    v_mfma_f32_16x16x32_bf16 v[40:43], v[80:83], v[180:183], v[40:43]
    ds_read_b64_tr_b16 v[66:67], v4 offset:18432
    v_cvt_pk_bf16_f32 v49, v18, v19
    v_fma_f32 v52, v52, v10, v28
    v_fma_f32 v53, v53, v10, v29
    v_fma_f32 v54, v54, v10, v30
    v_mfma_f32_16x16x32_bf16 v[44:47], v[84:87], v[180:183], v[44:47]
    ds_read_b64_tr_b16 v[68:69], v5 offset:16384
    v_fma_f32 v55, v55, v10, v31
    v_fma_f32 v20, -v52, v52, s80
    v_fma_f32 v21, -v53, v53, s80
    v_mfma_f32_16x16x32_bf16 v[36:39], v[84:87], v[176:179], v[36:39]
    ds_read_b64_tr_b16 v[70:71], v5 offset:18432
    v_fma_f32 v22, -v54, v54, s80
    v_fma_f32 v23, -v55, v55, s80
    v_mul_f32 v20, v52, v20
    v_mul_f32 v21, v53, v21
    s_waitcnt lgkmcnt(4)
    v_mfma_f32_16x16x32_bf16 v[32:35], v[88:91], v[184:187], v[32:35]
    ds_read_b64_tr_b16 v[72:73], v4 offset:20480
    v_mul_f32 v22, v54, v22
    v_mul_f32 v23, v55, v23
    v_exp_f32 v20, v20
    v_mfma_f32_16x16x32_bf16 v[40:43], v[88:91], v[188:191], v[40:43]
    ds_read_b64_tr_b16 v[74:75], v4 offset:22528
    v_exp_f32 v21, v21
    v_exp_f32 v22, v22
    v_exp_f32 v23, v23
    v_mfma_f32_16x16x32_bf16 v[44:47], v[92:95], v[188:191], v[44:47]
    ds_read_b64_tr_b16 v[76:77], v5 offset:20480
    v_add_f32 v20, 1.0, v20
    v_add_f32 v21, 1.0, v21
    v_add_f32 v22, 1.0, v22
    v_mfma_f32_16x16x32_bf16 v[36:39], v[92:95], v[184:187], v[36:39]
    ds_read_b64_tr_b16 v[78:79], v5 offset:22528
    v_add_f32 v23, 1.0, v23
    v_rcp_f32 v20, v20
    v_rcp_f32 v21, v21
    v_rcp_f32 v22, v22
    s_barrier
    s_waitcnt lgkmcnt(4)
    v_mfma_f32_16x16x32_bf16 v[32:35], v[64:67], v[192:195], v[32:35]
    ds_read_b64_tr_b16 v[80:81], v4 offset:24576
    v_rcp_f32 v23, v23
    v_mul_f32 v20, v52, v20
    v_mul_f32 v21, v53, v21
    v_mfma_f32_16x16x32_bf16 v[40:43], v[64:67], v[196:199], v[40:43]
    ds_read_b64_tr_b16 v[82:83], v4 offset:26624
    v_mul_f32 v22, v54, v22
    v_mul_f32 v23, v55, v23
    v_cvt_pk_bf16_f32 v50, v20, v21
    v_cvt_pk_bf16_f32 v51, v22, v23
    v_mfma_f32_16x16x32_bf16 v[44:47], v[68:71], v[196:199], v[44:47]
    ds_read_b64_tr_b16 v[84:85], v5 offset:24576
    v_fma_f32 v56, v56, v11, v24
    v_fma_f32 v57, v57, v11, v25
    v_fma_f32 v58, v58, v11, v26
    v_mfma_f32_16x16x32_bf16 v[36:39], v[68:71], v[192:195], v[36:39]
    ds_read_b64_tr_b16 v[86:87], v5 offset:26624
    v_fma_f32 v59, v59, v11, v27
    v_fma_f32 v16, -v56, v56, s80
    v_fma_f32 v17, -v57, v57, s80
    s_add_u32 m0, s66, 73728
    s_add_u32 s74, s85, 221184
    buffer_load_dwordx4 v3, s[16:19], s74 offen  lds
    s_waitcnt lgkmcnt(4)
    v_mfma_f32_16x16x32_bf16 v[32:35], v[72:75], v[200:203], v[32:35]
    ds_read_b64_tr_b16 v[88:89], v4 offset:28672
    v_fma_f32 v18, -v58, v58, s80
    v_fma_f32 v19, -v59, v59, s80
    v_mul_f32 v16, v56, v16
    v_mul_f32 v17, v57, v17
    v_mfma_f32_16x16x32_bf16 v[40:43], v[72:75], v[204:207], v[40:43]
    ds_read_b64_tr_b16 v[90:91], v4 offset:30720
    v_mul_f32 v18, v58, v18
    v_mul_f32 v19, v59, v19
    v_exp_f32 v16, v16
    v_exp_f32 v17, v17
    v_mfma_f32_16x16x32_bf16 v[44:47], v[76:79], v[204:207], v[44:47]
    ds_read_b64_tr_b16 v[92:93], v5 offset:28672
    v_exp_f32 v18, v18
    v_exp_f32 v19, v19
    v_add_f32 v16, 1.0, v16
    v_add_f32 v17, 1.0, v17
    v_mfma_f32_16x16x32_bf16 v[36:39], v[76:79], v[200:203], v[36:39]
    ds_read_b64_tr_b16 v[94:95], v5 offset:30720
    v_add_f32 v18, 1.0, v18
    v_add_f32 v19, 1.0, v19
    ds_write_b128 v9, v[48:51] offset:0
    s_add_u32 m0, s66, 81920
    s_add_u32 s74, s85, 294912
    buffer_load_dwordx4 v3, s[16:19], s74 offen  lds
    s_add_u32 m0, s66, 90112
    s_add_u32 s74, s85, 368640
    buffer_load_dwordx4 v3, s[16:19], s74 offen  lds
    s_waitcnt lgkmcnt(5)
    v_mfma_f32_16x16x32_bf16 v[32:35], v[80:83], v[208:211], v[32:35]
    ds_read_b64_tr_b16 v[64:65], v4 offset:32768
    v_rcp_f32 v16, v16
    v_rcp_f32 v17, v17
    v_rcp_f32 v18, v18
    v_rcp_f32 v19, v19
    v_mfma_f32_16x16x32_bf16 v[40:43], v[80:83], v[212:215], v[40:43]
    ds_read_b64_tr_b16 v[66:67], v4 offset:34816
    v_mul_f32 v16, v56, v16
    v_mul_f32 v17, v57, v17
    v_mul_f32 v18, v58, v18
    v_mul_f32 v19, v59, v19
    v_mfma_f32_16x16x32_bf16 v[44:47], v[84:87], v[212:215], v[44:47]
    ds_read_b64_tr_b16 v[68:69], v5 offset:32768
    v_cvt_pk_bf16_f32 v56, v16, v17
    v_cvt_pk_bf16_f32 v57, v18, v19
    v_fma_f32 v60, v60, v11, v28
    v_fma_f32 v61, v61, v11, v29
    v_mfma_f32_16x16x32_bf16 v[36:39], v[84:87], v[208:211], v[36:39]
    ds_read_b64_tr_b16 v[70:71], v5 offset:34816
    v_fma_f32 v62, v62, v11, v30
    s_add_u32 s85, s85, 128
    s_add_u32 m0, s66, 98304
    s_add_u32 s74, s85, 0
    buffer_load_dwordx4 v3, s[16:19], s74 offen  lds
    s_add_u32 m0, s66, 106496
    s_add_u32 s74, s85, 73728
    buffer_load_dwordx4 v3, s[16:19], s74 offen  lds
    s_waitcnt lgkmcnt(5)
    v_mfma_f32_16x16x32_bf16 v[32:35], v[88:91], v[216:219], v[32:35]
    ds_read_b64_tr_b16 v[72:73], v4 offset:36864
    v_fma_f32 v63, v63, v11, v31
    v_fma_f32 v20, -v60, v60, s80
    v_fma_f32 v21, -v61, v61, s80
    v_mfma_f32_16x16x32_bf16 v[40:43], v[88:91], v[220:223], v[40:43]
    ds_read_b64_tr_b16 v[74:75], v4 offset:38912
    v_fma_f32 v22, -v62, v62, s80
    v_fma_f32 v23, -v63, v63, s80
    v_mul_f32 v20, v60, v20
    v_mul_f32 v21, v61, v21
    v_mfma_f32_16x16x32_bf16 v[44:47], v[92:95], v[220:223], v[44:47]
    ds_read_b64_tr_b16 v[76:77], v5 offset:36864
    v_mul_f32 v22, v62, v22
    v_mul_f32 v23, v63, v23
    v_exp_f32 v20, v20
    v_mfma_f32_16x16x32_bf16 v[36:39], v[92:95], v[216:219], v[36:39]
    ds_read_b64_tr_b16 v[78:79], v5 offset:38912
    v_exp_f32 v21, v21
    v_exp_f32 v22, v22
    v_exp_f32 v23, v23
    s_add_u32 m0, s66, 114688
    s_add_u32 s74, s85, 147456
    buffer_load_dwordx4 v3, s[16:19], s74 offen  lds
    s_waitcnt lgkmcnt(4)
    v_mfma_f32_16x16x32_bf16 v[32:35], v[64:67], v[224:227], v[32:35]
    ds_read_b64_tr_b16 v[80:81], v4 offset:40960
    v_add_f32 v20, 1.0, v20
    v_add_f32 v21, 1.0, v21
    v_add_f32 v22, 1.0, v22
    v_add_f32 v23, 1.0, v23
    v_mfma_f32_16x16x32_bf16 v[40:43], v[64:67], v[228:231], v[40:43]
    ds_read_b64_tr_b16 v[82:83], v4 offset:43008
    v_rcp_f32 v20, v20
    v_rcp_f32 v21, v21
    v_rcp_f32 v22, v22
    v_rcp_f32 v23, v23
    v_mul_f32 v20, v60, v20
    v_mfma_f32_16x16x32_bf16 v[44:47], v[68:71], v[228:231], v[44:47]
    ds_read_b64_tr_b16 v[84:85], v5 offset:40960
    v_mul_f32 v21, v61, v21
    v_mul_f32 v22, v62, v22
    v_mul_f32 v23, v63, v23
    v_cvt_pk_bf16_f32 v58, v20, v21
    v_mfma_f32_16x16x32_bf16 v[36:39], v[68:71], v[224:227], v[36:39]
    ds_read_b64_tr_b16 v[86:87], v5 offset:43008
    v_cvt_pk_bf16_f32 v59, v22, v23
    ds_write_b128 v9, v[56:59] offset:1024
    v_subrev_u32 v14, 73728, v2
    s_add_u32 m0, s66, 122880
    s_add_u32 s74, s85, 221184
    buffer_load_dwordx4 v3, s[16:19], s74 offen  lds
    s_add_u32 m0, s66, 131072
    s_add_u32 s74, s85, 294912
    buffer_load_dwordx4 v3, s[16:19], s74 offen  lds
    s_waitcnt vmcnt(11) lgkmcnt(0)
    s_cmp_lg_u32 s93, 0
    s_cbranch_scc1 L_civ9_x
    v_cmp_ne_u32 vcc, 1, v12
    s_cbranch_vccz L_civ9_x
    s_lshl_b32 s76, s6, 4
    s_mov_b64 exec, 1
    s_mov_b32 s78, 0x100000
L_civ9r:
    v_mov_b32 v12, 0
    buffer_atomic_or v12, off, s[28:31], s76 offset:0 sc0
    s_sub_u32 s78, s78, 1
    s_cbranch_scc1 L_civ9r_x
    s_waitcnt vmcnt(0)
    v_cmp_ne_u32 vcc, 1, v12
    s_cbranch_vccnz L_civ9r
L_civ9r_x:
    s_mov_b64 exec, -1
L_civ9_x:
    s_barrier
    v_mfma_f32_16x16x32_bf16 v[32:35], v[72:75], v[232:235], v[32:35]
    ds_read_b64_tr_b16 v[88:89], v4 offset:45056
    ds_read_b128 v[240:243], v14 offset:0
    v_mfma_f32_16x16x32_bf16 v[40:43], v[72:75], v[236:239], v[40:43]
    ds_read_b64_tr_b16 v[90:91], v4 offset:47104
    ds_read_b128 v[244:247], v14 offset:1024
    ds_read_b128 v[248:251], v14 offset:8192
    v_mfma_f32_16x16x32_bf16 v[44:47], v[76:79], v[236:239], v[44:47]
    ds_read_b64_tr_b16 v[92:93], v5 offset:45056
    ds_read_b128 v[252:255], v14 offset:9216
    s_add_u32 m0, s66, 139264
    s_add_u32 s74, s85, 368640
    buffer_load_dwordx4 v3, s[16:19], s74 offen  lds
    v_mfma_f32_16x16x32_bf16 v[36:39], v[76:79], v[232:235], v[36:39]
    ds_read_b64_tr_b16 v[94:95], v5 offset:47104
    v_lshrrev_b32 v28, 5, v1
    v_lshlrev_b32 v8, 6, v28
    v_bfe_u32 v28, v1, 3, 2
    v_lshl_add_u32 v8, v28, 3, v8
    v_and_b32 v28, 7, v1
    s_lshl_b32 s76, s7, 3
    s_lshl_b32 s100, s6, 7
    s_add_u32 s76, s76, s100
    v_add_u32 v28, s76, v28
    v_mul_u32_u24 v31, 1152, v28
    v_add_u32 v31, v31, v8
    s_lshl_b32 s100, s100, 4
    s_add_u32 s100, s100, 41943040
    s_mov_b32 s92, s93
    s_lshl_b32 s76, s6, 4
    s_add_u32 s76, s76, s7
    s_mul_i32 s76, s76, 9
    s_add_u32 s76, s76, s92
    s_lshl_b32 s101, s76, 14
    s_sub_u32 s98, 6, s92
    s_max_i32 s98, s98, -1
    s_mov_b32 s99, 0
    v_mov_b32 v28, 0
    v_lshlrev_b32 v30, 4, v1
    s_lshl_b32 s76, s6, 4
    s_add_u32 s76, s76, s7
    s_mul_i32 s76, s76, 9216
    s_lshl_b32 s77, s93, 10
    s_add_u32 s75, s76, s77
    s_add_u32 m0, s77, 147456
    s_nop 0
    buffer_load_dwordx4 v30, s[8:11], s75 offen  lds
    s_cmp_gt_u32 s93, 4
    s_cbranch_scc1 L_bd10
    s_cmp_lg_u32 s93, 4
    s_cbranch_scc1 L_bd10v
    s_mov_b32 m0, 155648
    s_add_u32 s75, s76, 8192
    buffer_load_dwordx4 v30, s[8:11], s75 offen lds
    s_branch L_bd10
L_bd10v:
    s_bitcmp1_b32 s93, 1
    s_cselect_b32 s68, s58, s48
    s_cselect_b32 s69, s59, s49
    s_mov_b32 s70, 1152
    s_mov_b32 s71, 0x20000
    s_and_b32 s75, s77, 1024
    s_add_u32 m0, s77, 158208
    s_nop 0
    buffer_load_dwordx4 v30, s[68:71], s75 offen  lds
L_bd10:
    s_waitcnt lgkmcnt(1)
    s_mov_b32 s82, 0
    s_mov_b32 s78, 8
    s_mul_i32 s76, s5, 36864
    v_subrev_u32 v3, s76, v3
    s_lshl_b32 s66, s4, 10
    s_cmp_lt_u32 s93, 4
    s_cbranch_scc1 L_p2A_entry
L_p2B_entry:
    s_add_u32 s83, s82, s66
    s_add_u32 s82, s82, 49152
    s_cmp_ge_u32 s82, 147456
    s_cselect_b32 s82, 0, s82
    v_add_u32 v6, s82, v4
    v_add_u32 v7, s82, v5
    s_add_u32 s85, s85, 128
    s_waitcnt vmcnt(6)
.p2align 3
L_p2B:
    s_waitcnt lgkmcnt(0)
    s_setprio 1
    s_barrier
    s_cmp_le_u32 s78, 2
    s_cbranch_scc1 L_p2_ndB0
    s_add_u32 m0, s83, 0
    s_add_u32 s74, s85, 0
    buffer_load_dwordx4 v3, s[16:19], s74 offen  lds
L_p2_ndB0:
    v_mfma_f32_16x16x32_bf16 v[32:35], v[80:83], v[240:243], v[32:35]
    ds_read_b64_tr_b16 v[64:65], v6 offset:0
    v_mfma_f32_16x16x32_bf16 v[40:43], v[80:83], v[244:247], v[40:43]
    ds_read_b64_tr_b16 v[66:67], v6 offset:2048
    v_mfma_f32_16x16x32_bf16 v[44:47], v[84:87], v[244:247], v[44:47]
    ds_read_b64_tr_b16 v[68:69], v7 offset:0
    v_mfma_f32_16x16x32_bf16 v[36:39], v[84:87], v[240:243], v[36:39]
    ds_read_b64_tr_b16 v[70:71], v7 offset:2048
    v_mfma_f32_16x16x32_bf16 v[48:51], v[88:91], v[248:251], v[32:35]
    ds_read_b64_tr_b16 v[72:73], v6 offset:4096
    v_mfma_f32_16x16x32_bf16 v[56:59], v[88:91], v[252:255], v[40:43]
    ds_read_b64_tr_b16 v[74:75], v6 offset:6144
    v_mfma_f32_16x16x32_bf16 v[60:63], v[92:95], v[252:255], v[44:47]
    ds_read_b64_tr_b16 v[76:77], v7 offset:4096
    v_mfma_f32_16x16x32_bf16 v[52:55], v[92:95], v[248:251], v[36:39]
    ds_read_b64_tr_b16 v[78:79], v7 offset:6144
    s_setprio 0
    s_sub_u32 s77, 7, s78
    s_cmp_lg_u32 s93, 7
    s_cbranch_scc1 L_fs13
    s_cmp_lt_i32 s77, 0
    s_cbranch_scc1 L_fs13
    s_lshl_b32 s77, s77, 7
    s_add_u32 s77, s77, s100
    v_mov_b32 v9, 1
    s_mov_b64 exec, 1
    buffer_atomic_add v9, off, s[20:23], s77 offset:0
    s_mov_b64 exec, -1
L_fs13:
    v_readfirstlane_b32 s99, v28
    s_lshr_b32 s99, s99, 4
    s_cbranch_scc1 L_p2_nofl
    s_cmp_gt_i32 s78, s98
    s_cbranch_scc1 L_fl14
    s_lshl_b32 s77, s92, 7
    s_add_u32 s77, s77, s100
    v_mov_b32 v28, 0
    s_mov_b64 exec, 1
    buffer_atomic_add v28, off, s[20:23], s77 sc0
    s_mov_b64 exec, -1
L_fl14:
L_p2_nofl:
    s_nop 1
    v_cvt_pk_bf16_f32 v48, v48, v49
    v_cvt_pk_bf16_f32 v49, v50, v51
    v_cvt_pk_bf16_f32 v50, v52, v53
    v_cvt_pk_bf16_f32 v51, v54, v55
    s_add_u32 s75, s84, 0
    buffer_store_dwordx4 v[48:51], v13, s[20:23], s75 offen sc1
    v_cvt_pk_bf16_f32 v56, v56, v57
    v_cvt_pk_bf16_f32 v57, v58, v59
    v_cvt_pk_bf16_f32 v58, v60, v61
    v_cvt_pk_bf16_f32 v59, v62, v63
    s_add_u32 s75, s84, s89
    buffer_store_dwordx4 v[56:59], v13, s[20:23], s75 offen sc1
    s_add_u32 s84, s84, 16384
    s_cmp_eq_u32 s99, 0
    s_cbranch_scc1 L_p2_nop
    s_add_u32 s76, s101, 0
    buffer_load_dwordx4 v[96:99], v30, s[20:23], s76 offen offset:0 sc1
    buffer_load_dwordx4 v[100:103], v30, s[20:23], s76 offen offset:1024 sc1
    buffer_load_dwordx4 v[104:107], v30, s[20:23], s76 offen offset:2048 sc1
    buffer_load_dwordx4 v[108:111], v30, s[20:23], s76 offen offset:3072 sc1
    s_add_u32 s76, s101, 4096
    buffer_load_dwordx4 v[112:115], v30, s[20:23], s76 offen offset:0 sc1
    buffer_load_dwordx4 v[116:119], v30, s[20:23], s76 offen offset:1024 sc1
    buffer_load_dwordx4 v[120:123], v30, s[20:23], s76 offen offset:2048 sc1
    buffer_load_dwordx4 v[124:127], v30, s[20:23], s76 offen offset:3072 sc1
    s_add_u32 s76, s101, 8192
    buffer_load_dwordx4 v[128:131], v30, s[20:23], s76 offen offset:0 sc1
    buffer_load_dwordx4 v[132:135], v30, s[20:23], s76 offen offset:1024 sc1
    buffer_load_dwordx4 v[136:139], v30, s[20:23], s76 offen offset:2048 sc1
    buffer_load_dwordx4 v[140:143], v30, s[20:23], s76 offen offset:3072 sc1
    s_add_u32 s76, s101, 12288
    buffer_load_dwordx4 v[144:147], v30, s[20:23], s76 offen offset:0 sc1
    buffer_load_dwordx4 v[148:151], v30, s[20:23], s76 offen offset:1024 sc1
    buffer_load_dwordx4 v[152:155], v30, s[20:23], s76 offen offset:2048 sc1
    buffer_load_dwordx4 v[156:159], v30, s[20:23], s76 offen offset:3072 sc1
    s_mov_b32 s98, -2
    v_mov_b32 v28, 0
L_p2_nop:
    s_cmp_le_u32 s78, 2
    s_cbranch_scc1 L_p2_ndB
    s_add_u32 m0, s83, 4096
    s_add_u32 s74, s85, 36864
    buffer_load_dwordx4 v3, s[16:19], s74 offen  lds
    s_add_u32 m0, s83, 8192
    s_add_u32 s74, s85, 73728
    buffer_load_dwordx4 v3, s[16:19], s74 offen  lds
    s_add_u32 m0, s83, 12288
    s_add_u32 s74, s85, 110592
    buffer_load_dwordx4 v3, s[16:19], s74 offen  lds
    s_add_u32 m0, s83, 16384
    s_add_u32 s74, s85, 147456
    buffer_load_dwordx4 v3, s[16:19], s74 offen  lds
    s_add_u32 m0, s83, 20480
    s_add_u32 s74, s85, 184320
    buffer_load_dwordx4 v3, s[16:19], s74 offen  lds
    s_add_u32 m0, s83, 24576
    s_add_u32 s74, s85, 221184
    buffer_load_dwordx4 v3, s[16:19], s74 offen  lds
    s_add_u32 m0, s83, 28672
    s_add_u32 s74, s85, 258048
    buffer_load_dwordx4 v3, s[16:19], s74 offen  lds
    s_add_u32 m0, s83, 32768
    s_add_u32 s74, s85, 294912
    buffer_load_dwordx4 v3, s[16:19], s74 offen  lds
L_p2_ndB:
    s_waitcnt lgkmcnt(4)
    v_mfma_f32_16x16x32_bf16 v[32:35], v[64:67], v[160:163], 0
    ds_read_b64_tr_b16 v[80:81], v6 offset:8192
    ds_read_b64_tr_b16 v[82:83], v6 offset:10240
    v_mfma_f32_16x16x32_bf16 v[40:43], v[64:67], v[164:167], 0
    ds_read_b64_tr_b16 v[84:85], v7 offset:8192
    ds_read_b64_tr_b16 v[86:87], v7 offset:10240
    v_mfma_f32_16x16x32_bf16 v[44:47], v[68:71], v[164:167], 0
    ds_read_b64_tr_b16 v[88:89], v6 offset:12288
    ds_read_b64_tr_b16 v[90:91], v6 offset:14336
    v_mfma_f32_16x16x32_bf16 v[36:39], v[68:71], v[160:163], 0
    ds_read_b64_tr_b16 v[92:93], v7 offset:12288
    ds_read_b64_tr_b16 v[94:95], v7 offset:14336
    s_waitcnt lgkmcnt(8)
    v_mfma_f32_16x16x32_bf16 v[32:35], v[72:75], v[168:171], v[32:35]
    ds_read_b64_tr_b16 v[64:65], v6 offset:16384
    v_mfma_f32_16x16x32_bf16 v[40:43], v[72:75], v[172:175], v[40:43]
    ds_read_b64_tr_b16 v[66:67], v6 offset:18432
    v_mfma_f32_16x16x32_bf16 v[44:47], v[76:79], v[172:175], v[44:47]
    ds_read_b64_tr_b16 v[68:69], v7 offset:16384
    v_mfma_f32_16x16x32_bf16 v[36:39], v[76:79], v[168:171], v[36:39]
    ds_read_b64_tr_b16 v[70:71], v7 offset:18432
    s_waitcnt lgkmcnt(8)
    v_mfma_f32_16x16x32_bf16 v[32:35], v[80:83], v[176:179], v[32:35]
    ds_read_b64_tr_b16 v[72:73], v6 offset:20480
    v_mfma_f32_16x16x32_bf16 v[40:43], v[80:83], v[180:183], v[40:43]
    ds_read_b64_tr_b16 v[74:75], v6 offset:22528
    v_mfma_f32_16x16x32_bf16 v[44:47], v[84:87], v[180:183], v[44:47]
    ds_read_b64_tr_b16 v[76:77], v7 offset:20480
    v_mfma_f32_16x16x32_bf16 v[36:39], v[84:87], v[176:179], v[36:39]
    ds_read_b64_tr_b16 v[78:79], v7 offset:22528
    s_waitcnt lgkmcnt(8)
    v_mfma_f32_16x16x32_bf16 v[32:35], v[88:91], v[184:187], v[32:35]
    ds_read_b64_tr_b16 v[80:81], v6 offset:24576
    v_mfma_f32_16x16x32_bf16 v[40:43], v[88:91], v[188:191], v[40:43]
    ds_read_b64_tr_b16 v[82:83], v6 offset:26624
    v_mfma_f32_16x16x32_bf16 v[44:47], v[92:95], v[188:191], v[44:47]
    ds_read_b64_tr_b16 v[84:85], v7 offset:24576
    v_mfma_f32_16x16x32_bf16 v[36:39], v[92:95], v[184:187], v[36:39]
    ds_read_b64_tr_b16 v[86:87], v7 offset:26624
    s_waitcnt lgkmcnt(8)
    v_mfma_f32_16x16x32_bf16 v[32:35], v[64:67], v[192:195], v[32:35]
    ds_read_b64_tr_b16 v[88:89], v6 offset:28672
    v_mfma_f32_16x16x32_bf16 v[40:43], v[64:67], v[196:199], v[40:43]
    ds_read_b64_tr_b16 v[90:91], v6 offset:30720
    v_mfma_f32_16x16x32_bf16 v[44:47], v[68:71], v[196:199], v[44:47]
    ds_read_b64_tr_b16 v[92:93], v7 offset:28672
    v_mfma_f32_16x16x32_bf16 v[36:39], v[68:71], v[192:195], v[36:39]
    ds_read_b64_tr_b16 v[94:95], v7 offset:30720
    s_waitcnt lgkmcnt(8)
    v_mfma_f32_16x16x32_bf16 v[32:35], v[72:75], v[200:203], v[32:35]
    ds_read_b64_tr_b16 v[64:65], v6 offset:32768
    v_mfma_f32_16x16x32_bf16 v[40:43], v[72:75], v[204:207], v[40:43]
    ds_read_b64_tr_b16 v[66:67], v6 offset:34816
    v_mfma_f32_16x16x32_bf16 v[44:47], v[76:79], v[204:207], v[44:47]
    ds_read_b64_tr_b16 v[68:69], v7 offset:32768
    v_mfma_f32_16x16x32_bf16 v[36:39], v[76:79], v[200:203], v[36:39]
    ds_read_b64_tr_b16 v[70:71], v7 offset:34816
    s_waitcnt lgkmcnt(8)
    v_mfma_f32_16x16x32_bf16 v[32:35], v[80:83], v[208:211], v[32:35]
    ds_read_b64_tr_b16 v[72:73], v6 offset:36864
    v_mfma_f32_16x16x32_bf16 v[40:43], v[80:83], v[212:215], v[40:43]
    ds_read_b64_tr_b16 v[74:75], v6 offset:38912
    v_mfma_f32_16x16x32_bf16 v[44:47], v[84:87], v[212:215], v[44:47]
    ds_read_b64_tr_b16 v[76:77], v7 offset:36864
    v_mfma_f32_16x16x32_bf16 v[36:39], v[84:87], v[208:211], v[36:39]
    ds_read_b64_tr_b16 v[78:79], v7 offset:38912
    s_waitcnt lgkmcnt(8)
    v_mfma_f32_16x16x32_bf16 v[32:35], v[88:91], v[216:219], v[32:35]
    ds_read_b64_tr_b16 v[80:81], v6 offset:40960
    v_mfma_f32_16x16x32_bf16 v[40:43], v[88:91], v[220:223], v[40:43]
    ds_read_b64_tr_b16 v[82:83], v6 offset:43008
    v_mfma_f32_16x16x32_bf16 v[44:47], v[92:95], v[220:223], v[44:47]
    ds_read_b64_tr_b16 v[84:85], v7 offset:40960
    v_mfma_f32_16x16x32_bf16 v[36:39], v[92:95], v[216:219], v[36:39]
    ds_read_b64_tr_b16 v[86:87], v7 offset:43008
    s_waitcnt lgkmcnt(8)
    v_mfma_f32_16x16x32_bf16 v[32:35], v[64:67], v[224:227], v[32:35]
    ds_read_b64_tr_b16 v[88:89], v6 offset:45056
    v_mfma_f32_16x16x32_bf16 v[40:43], v[64:67], v[228:231], v[40:43]
    ds_read_b64_tr_b16 v[90:91], v6 offset:47104
    v_mfma_f32_16x16x32_bf16 v[44:47], v[68:71], v[228:231], v[44:47]
    ds_read_b64_tr_b16 v[92:93], v7 offset:45056
    v_mfma_f32_16x16x32_bf16 v[36:39], v[68:71], v[224:227], v[36:39]
    ds_read_b64_tr_b16 v[94:95], v7 offset:47104
    s_waitcnt lgkmcnt(8)
    v_mfma_f32_16x16x32_bf16 v[32:35], v[72:75], v[232:235], v[32:35]
    v_mfma_f32_16x16x32_bf16 v[40:43], v[72:75], v[236:239], v[40:43]
    v_mfma_f32_16x16x32_bf16 v[44:47], v[76:79], v[236:239], v[44:47]
    v_mfma_f32_16x16x32_bf16 v[36:39], v[76:79], v[232:235], v[36:39]
    s_add_u32 s83, s82, s66
    s_add_u32 s82, s82, 49152
    s_cmp_ge_u32 s82, 147456
    s_cselect_b32 s82, 0, s82
    v_add_u32 v6, s82, v4
    v_add_u32 v7, s82, v5
    s_add_u32 s85, s85, 128
    s_sub_u32 s78, s78, 1
    s_cmp_lg_u32 s99, 0
    s_cbranch_scc1 L_p2_j
    s_cmp_le_u32 s78, 1
    s_cbranch_scc1 L_p2_w2
    s_waitcnt vmcnt(8)
    s_branch L_p2B
L_p2_j:
    s_mov_b32 s99, 0
    s_cmp_le_u32 s78, 1
    s_cbranch_scc1 L_p2_w3
    s_waitcnt vmcnt(24)
    s_branch L_p2B
L_p2_w2:
    s_waitcnt vmcnt(0)
L_p2_w3:
    s_waitcnt vmcnt(16)
    s_cmp_lg_u32 s78, 0
    s_cbranch_scc1 L_p2B
    s_waitcnt lgkmcnt(4)
    v_mfma_f32_16x16x32_bf16 v[32:35], v[80:83], v[240:243], v[32:35]
    v_mfma_f32_16x16x32_bf16 v[40:43], v[80:83], v[244:247], v[40:43]
    v_mfma_f32_16x16x32_bf16 v[44:47], v[84:87], v[244:247], v[44:47]
    v_mfma_f32_16x16x32_bf16 v[36:39], v[84:87], v[240:243], v[36:39]
    s_waitcnt lgkmcnt(0)
    v_mfma_f32_16x16x32_bf16 v[48:51], v[88:91], v[248:251], v[32:35]
    v_mfma_f32_16x16x32_bf16 v[56:59], v[88:91], v[252:255], v[40:43]
    v_mfma_f32_16x16x32_bf16 v[60:63], v[92:95], v[252:255], v[44:47]
    v_mfma_f32_16x16x32_bf16 v[52:55], v[92:95], v[248:251], v[36:39]
    v_readfirstlane_b32 s77, v28
    s_lshr_b32 s77, s77, 4
    s_cbranch_scc1 L_p2_nofl2
    s_cmp_gt_i32 s78, s98
    s_cbranch_scc1 L_fl15
    s_lshl_b32 s77, s92, 7
    s_add_u32 s77, s77, s100
    v_mov_b32 v28, 0
    s_mov_b64 exec, 1
    buffer_atomic_add v28, off, s[20:23], s77 sc0
    s_mov_b64 exec, -1
L_fl15:
L_p2_nofl2:
    s_nop 4
    v_cvt_pk_bf16_f32 v48, v48, v49
    v_cvt_pk_bf16_f32 v49, v50, v51
    v_cvt_pk_bf16_f32 v50, v52, v53
    v_cvt_pk_bf16_f32 v51, v54, v55
    s_add_u32 s75, s84, 0
    buffer_store_dwordx4 v[48:51], v13, s[20:23], s75 offen sc1
    v_cvt_pk_bf16_f32 v56, v56, v57
    v_cvt_pk_bf16_f32 v57, v58, v59
    v_cvt_pk_bf16_f32 v58, v60, v61
    v_cvt_pk_bf16_f32 v59, v62, v63
    s_add_u32 s75, s84, s89
    buffer_store_dwordx4 v[56:59], v13, s[20:23], s75 offen sc1
    s_add_u32 s84, s84, 16384
    s_barrier
L_p2_done:
L_reduce:
    v_and_b32 v186, 7, v1
    s_lshl_b32 s76, s7, 6
    s_add_u32 s76, s76, 157184
    v_lshlrev_b32 v42, 3, v186
    v_add_u32 v42, s76, v42
    ds_read_b64 v[40:41], v42
    s_lshl_b32 s77, s92, 7
    s_add_u32 s77, s77, 147456
    v_add_u32 v43, s77, v8
    v_and_b32 v44, 7, v1
    v_mul_u32_u24 v44, 1152, v44
    v_add_u32 v44, v44, v43
    ds_read_b64 v[16:17], v44
    ds_read_b64 v[18:19], v44 offset:32
    ds_read_b64 v[20:21], v43 offset:10752
    ds_read_b64 v[22:23], v43 offset:10784
    ds_read_b64 v[24:25], v43 offset:12800
    ds_read_b64 v[26:27], v43 offset:12832
    v_and_b32 v187, 32, v1
    v_bfe_u32 v42, v1, 4, 1
    v_lshl_add_u32 v187, v42, 2, v187
    s_lshr_b32 s76, s93, 2
    s_lshl_b32 s76, s76, 6
    s_and_b32 s77, s93, 3
    s_lshl_b32 s77, s77, 3
    s_add_u32 s76, s76, s77
    s_add_u32 s76, s76, 1024
    v_add_u32 v187, s76, v187
    v_add_u32 v42, 147456, v187
    ds_read_b32 v181, v42 offset:10752
    ds_read_b32 v182, v42 offset:12800
    v_mul_u32_u24 v43, 1152, v186
    v_add_u32 v42, v42, v43
    ds_read_b32 v180, v42
    v_sub_u32 v42, v31, v8
    v_add_lshl_u32 v187, v187, v42, 1
    v_lshlrev_b32 v186, 4, v186
    v_lshrrev_b32 v42, 3, v1
    v_lshl_add_u32 v186, v42, 10, v186
    s_mov_b32 s32, 0x3f80
    s_mov_b32 s33, 0x3f800000
    s_mov_b32 s34, 0x40088e99
    s_sub_u32 s76, 8, s92
    s_lshl_b32 s76, s76, 14
    s_add_u32 s35, s101, s76
    s_lshl_b32 s76, s93, 7
    s_add_u32 s35, s35, s76
    v_and_b32 v42, 32, v1
    v_sub_u32 v42, v31, v42
    v_lshlrev_b32 v31, 1, v42
    s_waitcnt lgkmcnt(0)
    v_lshlrev_b32 v64, 16, v180
    v_and_b32 v65, s79, v180
    v_lshlrev_b32 v72, 16, v181
    v_and_b32 v73, s79, v181
    v_lshlrev_b32 v176, 16, v182
    v_and_b32 v177, s79, v182
    v_pk_add_f32 v[176:177], v[176:177], v[64:65]
    v_pk_add_f32 v[64:65], v[64:65], v[40:41] op_sel_hi:[1,0] neg_lo:[0,1] neg_hi:[0,1]
    v_pk_mul_f32 v[72:73], v[72:73], v[40:41] op_sel:[0,1] op_sel_hi:[1,1]
    v_pk_fma_f32 v[176:177], v[64:65], v[72:73], v[176:177]
    v_lshlrev_b32 v64, 16, v16
    v_and_b32 v65, s79, v16
    v_lshlrev_b32 v72, 16, v20
    v_and_b32 v73, s79, v20
    v_lshlrev_b32 v32, 16, v24
    v_and_b32 v33, s79, v24
    v_lshlrev_b32 v66, 16, v17
    v_and_b32 v67, s79, v17
    v_lshlrev_b32 v74, 16, v21
    v_and_b32 v75, s79, v21
    v_lshlrev_b32 v34, 16, v25
    v_and_b32 v35, s79, v25
    v_lshlrev_b32 v68, 16, v18
    v_and_b32 v69, s79, v18
    v_lshlrev_b32 v76, 16, v22
    v_and_b32 v77, s79, v22
    v_lshlrev_b32 v36, 16, v26
    v_and_b32 v37, s79, v26
    v_lshlrev_b32 v70, 16, v19
    v_and_b32 v71, s79, v19
    v_lshlrev_b32 v78, 16, v23
    v_and_b32 v79, s79, v23
    v_lshlrev_b32 v38, 16, v27
    v_and_b32 v39, s79, v27
    v_pk_add_f32 v[32:33], v[32:33], v[64:65]
    v_pk_add_f32 v[64:65], v[64:65], v[40:41] op_sel_hi:[1,0] neg_lo:[0,1] neg_hi:[0,1]
    v_pk_mul_f32 v[72:73], v[72:73], v[40:41] op_sel:[0,1] op_sel_hi:[1,1]
    v_pk_add_f32 v[34:35], v[34:35], v[66:67]
    v_pk_add_f32 v[66:67], v[66:67], v[40:41] op_sel_hi:[1,0] neg_lo:[0,1] neg_hi:[0,1]
    v_pk_mul_f32 v[74:75], v[74:75], v[40:41] op_sel:[0,1] op_sel_hi:[1,1]
    v_pk_add_f32 v[36:37], v[36:37], v[68:69]
    v_pk_add_f32 v[68:69], v[68:69], v[40:41] op_sel_hi:[1,0] neg_lo:[0,1] neg_hi:[0,1]
    v_pk_mul_f32 v[76:77], v[76:77], v[40:41] op_sel:[0,1] op_sel_hi:[1,1]
    v_pk_add_f32 v[38:39], v[38:39], v[70:71]
    v_pk_add_f32 v[70:71], v[70:71], v[40:41] op_sel_hi:[1,0] neg_lo:[0,1] neg_hi:[0,1]
    v_pk_mul_f32 v[78:79], v[78:79], v[40:41] op_sel:[0,1] op_sel_hi:[1,1]
    v_pk_fma_f32 v[32:33], v[64:65], v[72:73], v[32:33]
    v_pk_fma_f32 v[34:35], v[66:67], v[74:75], v[34:35]
    v_pk_fma_f32 v[36:37], v[68:69], v[76:77], v[36:37]
    v_pk_fma_f32 v[38:39], v[70:71], v[78:79], v[38:39]
    s_mov_b32 s40, 0
    s_cmp_lg_u32 s99, 0
    s_cbranch_scc1 L_rd_j
    s_waitcnt vmcnt(0)
    s_cmp_eq_i32 s98, -2
    s_cselect_b32 s40, s93, 0
L_rd_j:
    s_waitcnt vmcnt(16)
    s_cmp_ge_u32 s93, 4
    s_cbranch_scc1 L_rd_b
    s_barrier
    s_mov_b32 s77, 7
    s_cmp_lg_u32 s93, 0
    s_cbranch_scc1 L_fs23
    s_cmp_lt_i32 s77, 0
    s_cbranch_scc1 L_fs23
    s_lshl_b32 s77, s77, 7
    s_add_u32 s77, s77, s100
    v_mov_b32 v42, 1
    s_mov_b64 exec, 1
    buffer_atomic_add v42, off, s[20:23], s77 offset:0
    s_mov_b64 exec, -1
L_fs23:
    v_lshlrev_b32 v43, 7, v1
    s_add_u32 s41, s100, 196608
L_rd_b:
    s_barrier
    s_cmp_lg_u32 s93, 0
    s_cbranch_scc1 L_rd_nf8
    s_mov_b64 exec, 0xffff
    buffer_atomic_add v42, v43, s[20:23], s41 offen
    s_mov_b64 exec, -1
L_rd_nf8:
    s_cmp_gt_i32 s78, s98
    s_cbranch_scc1 L_tp24
    v_cmp_ne_u32 vcc, 16, v28
    s_and_b64 vcc, vcc, 1
    s_cbranch_vccnz L_tp24
    s_add_u32 s76, s101, 0
    buffer_load_dwordx4 v[96:99], v30, s[20:23], s76 offen offset:0 sc1
    buffer_load_dwordx4 v[100:103], v30, s[20:23], s76 offen offset:1024 sc1
    buffer_load_dwordx4 v[104:107], v30, s[20:23], s76 offen offset:2048 sc1
    buffer_load_dwordx4 v[108:111], v30, s[20:23], s76 offen offset:3072 sc1
    s_add_u32 s76, s101, 4096
    buffer_load_dwordx4 v[112:115], v30, s[20:23], s76 offen offset:0 sc1
    buffer_load_dwordx4 v[116:119], v30, s[20:23], s76 offen offset:1024 sc1
    buffer_load_dwordx4 v[120:123], v30, s[20:23], s76 offen offset:2048 sc1
    buffer_load_dwordx4 v[124:127], v30, s[20:23], s76 offen offset:3072 sc1
    s_add_u32 s76, s101, 8192
    buffer_load_dwordx4 v[128:131], v30, s[20:23], s76 offen offset:0 sc1
    buffer_load_dwordx4 v[132:135], v30, s[20:23], s76 offen offset:1024 sc1
    buffer_load_dwordx4 v[136:139], v30, s[20:23], s76 offen offset:2048 sc1
    buffer_load_dwordx4 v[140:143], v30, s[20:23], s76 offen offset:3072 sc1
    s_add_u32 s76, s101, 12288
    buffer_load_dwordx4 v[144:147], v30, s[20:23], s76 offen offset:0 sc1
    buffer_load_dwordx4 v[148:151], v30, s[20:23], s76 offen offset:1024 sc1
    buffer_load_dwordx4 v[152:155], v30, s[20:23], s76 offen offset:2048 sc1
    buffer_load_dwordx4 v[156:159], v30, s[20:23], s76 offen offset:3072 sc1
    s_mov_b32 s98, -2
    s_mov_b32 s99, 1
L_tp24:
    s_cmp_lg_u32 s40, 0
    s_cbranch_scc1 L_rd_sum
    s_cmp_eq_i32 s98, -2
    s_cbranch_scc1 L_rd_have
    s_lshl_b32 s77, s92, 7
    s_add_u32 s77, s77, s100
    s_mov_b32 s78, 0x100000
L_rd_poll:
    v_mov_b32 v28, 0
    s_mov_b64 exec, 1
    buffer_atomic_add v28, off, s[20:23], s77 sc0
    s_mov_b64 exec, -1
    s_sub_u32 s78, s78, 1
    s_cbranch_scc1 L_rd_poll_x
    s_waitcnt vmcnt(0)
    v_cmp_ne_u32 vcc, 16, v28
    s_and_b64 vcc, vcc, 1
    s_cbranch_vccnz L_rd_poll
L_rd_poll_x:
    s_add_u32 s76, s101, 0
    buffer_load_dwordx4 v[96:99], v30, s[20:23], s76 offen offset:0 sc1
    buffer_load_dwordx4 v[100:103], v30, s[20:23], s76 offen offset:1024 sc1
    buffer_load_dwordx4 v[104:107], v30, s[20:23], s76 offen offset:2048 sc1
    buffer_load_dwordx4 v[108:111], v30, s[20:23], s76 offen offset:3072 sc1
    s_add_u32 s76, s101, 4096
    buffer_load_dwordx4 v[112:115], v30, s[20:23], s76 offen offset:0 sc1
    buffer_load_dwordx4 v[116:119], v30, s[20:23], s76 offen offset:1024 sc1
    buffer_load_dwordx4 v[120:123], v30, s[20:23], s76 offen offset:2048 sc1
    buffer_load_dwordx4 v[124:127], v30, s[20:23], s76 offen offset:3072 sc1
    s_add_u32 s76, s101, 8192
    buffer_load_dwordx4 v[128:131], v30, s[20:23], s76 offen offset:0 sc1
    buffer_load_dwordx4 v[132:135], v30, s[20:23], s76 offen offset:1024 sc1
    buffer_load_dwordx4 v[136:139], v30, s[20:23], s76 offen offset:2048 sc1
    buffer_load_dwordx4 v[140:143], v30, s[20:23], s76 offen offset:3072 sc1
    s_add_u32 s76, s101, 12288
    buffer_load_dwordx4 v[144:147], v30, s[20:23], s76 offen offset:0 sc1
    buffer_load_dwordx4 v[148:151], v30, s[20:23], s76 offen offset:1024 sc1
    buffer_load_dwordx4 v[152:155], v30, s[20:23], s76 offen offset:2048 sc1
    buffer_load_dwordx4 v[156:159], v30, s[20:23], s76 offen offset:3072 sc1
L_rd_have:
    s_cmp_lg_u32 s93, 0
    s_cbranch_scc1 L_rd_np
    s_lshl_b32 s77, s7, 7
    s_add_u32 s77, s77, s100
    s_add_u32 s77, s77, 196608
    s_mov_b32 s78, 0x80000
    s_mov_b64 exec, 1
L_rd_p8:
    v_mov_b32 v224, 0
    buffer_atomic_add v224, off, s[20:23], s77 sc0
    s_waitcnt vmcnt(0)
    v_cmp_eq_u32 vcc, 16, v224
    s_cbranch_vccnz L_rd_p8x
    s_sub_u32 s78, s78, 1
    s_cbranch_scc0 L_rd_p8
L_rd_p8x:
    s_mov_b64 exec, -1
L_rd_np:
    s_barrier
    buffer_load_dwordx4 v[192:195], v186, s[20:23], s35 offen sc1
    s_add_u32 s35, s35, 8192
    buffer_load_dwordx4 v[196:199], v186, s[20:23], s35 offen sc1
    s_cmp_lg_u32 s40, 0
    s_cbranch_scc1 L_rd_last0
L_rd_sum:
    s_waitcnt vmcnt(17)
    v_lshlrev_b32 v160, 16, v96
    v_and_b32 v161, s79, v96
    v_lshlrev_b32 v162, 16, v97
    v_and_b32 v163, s79, v97
    v_lshlrev_b32 v164, 16, v98
    v_and_b32 v165, s79, v98
    v_lshlrev_b32 v166, 16, v99
    v_and_b32 v167, s79, v99
    s_waitcnt vmcnt(16)
    v_dot2c_f32_bf16 v160, s32, v100
    v_dot2c_f32_bf16 v161, s33, v100
    v_dot2c_f32_bf16 v162, s32, v101
    v_dot2c_f32_bf16 v163, s33, v101
    v_dot2c_f32_bf16 v164, s32, v102
    v_dot2c_f32_bf16 v165, s33, v102
    v_dot2c_f32_bf16 v166, s32, v103
    v_dot2c_f32_bf16 v167, s33, v103
    s_waitcnt vmcnt(15)
    v_dot2c_f32_bf16 v160, s32, v104
    v_dot2c_f32_bf16 v161, s33, v104
    v_dot2c_f32_bf16 v162, s32, v105
    v_dot2c_f32_bf16 v163, s33, v105
    v_dot2c_f32_bf16 v164, s32, v106
    v_dot2c_f32_bf16 v165, s33, v106
    v_dot2c_f32_bf16 v166, s32, v107
    v_dot2c_f32_bf16 v167, s33, v107
    s_waitcnt vmcnt(14)
    v_dot2c_f32_bf16 v160, s32, v108
    v_dot2c_f32_bf16 v161, s33, v108
    v_dot2c_f32_bf16 v162, s32, v109
    v_dot2c_f32_bf16 v163, s33, v109
    v_dot2c_f32_bf16 v164, s32, v110
    v_dot2c_f32_bf16 v165, s33, v110
    v_dot2c_f32_bf16 v166, s32, v111
    v_dot2c_f32_bf16 v167, s33, v111
    s_waitcnt vmcnt(13)
    v_dot2c_f32_bf16 v160, s32, v112
    v_dot2c_f32_bf16 v161, s33, v112
    v_dot2c_f32_bf16 v162, s32, v113
    v_dot2c_f32_bf16 v163, s33, v113
    v_dot2c_f32_bf16 v164, s32, v114
    v_dot2c_f32_bf16 v165, s33, v114
    v_dot2c_f32_bf16 v166, s32, v115
    v_dot2c_f32_bf16 v167, s33, v115
    s_waitcnt vmcnt(12)
    v_dot2c_f32_bf16 v160, s32, v116
    v_dot2c_f32_bf16 v161, s33, v116
    v_dot2c_f32_bf16 v162, s32, v117
    v_dot2c_f32_bf16 v163, s33, v117
    v_dot2c_f32_bf16 v164, s32, v118
    v_dot2c_f32_bf16 v165, s33, v118
    v_dot2c_f32_bf16 v166, s32, v119
    v_dot2c_f32_bf16 v167, s33, v119
    s_waitcnt vmcnt(11)
    v_dot2c_f32_bf16 v160, s32, v120
    v_dot2c_f32_bf16 v161, s33, v120
    v_dot2c_f32_bf16 v162, s32, v121
    v_dot2c_f32_bf16 v163, s33, v121
    v_dot2c_f32_bf16 v164, s32, v122
    v_dot2c_f32_bf16 v165, s33, v122
    v_dot2c_f32_bf16 v166, s32, v123
    v_dot2c_f32_bf16 v167, s33, v123
    s_waitcnt vmcnt(10)
    v_dot2c_f32_bf16 v160, s32, v124
    v_dot2c_f32_bf16 v161, s33, v124
    v_dot2c_f32_bf16 v162, s32, v125
    v_dot2c_f32_bf16 v163, s33, v125
    v_dot2c_f32_bf16 v164, s32, v126
    v_dot2c_f32_bf16 v165, s33, v126
    v_dot2c_f32_bf16 v166, s32, v127
    v_dot2c_f32_bf16 v167, s33, v127
    s_waitcnt vmcnt(9)
    v_dot2c_f32_bf16 v160, s32, v128
    v_dot2c_f32_bf16 v161, s33, v128
    v_dot2c_f32_bf16 v162, s32, v129
    v_dot2c_f32_bf16 v163, s33, v129
    v_dot2c_f32_bf16 v164, s32, v130
    v_dot2c_f32_bf16 v165, s33, v130
    v_dot2c_f32_bf16 v166, s32, v131
    v_dot2c_f32_bf16 v167, s33, v131
    s_waitcnt vmcnt(8)
    v_dot2c_f32_bf16 v160, s32, v132
    v_dot2c_f32_bf16 v161, s33, v132
    v_dot2c_f32_bf16 v162, s32, v133
    v_dot2c_f32_bf16 v163, s33, v133
    v_dot2c_f32_bf16 v164, s32, v134
    v_dot2c_f32_bf16 v165, s33, v134
    v_dot2c_f32_bf16 v166, s32, v135
    v_dot2c_f32_bf16 v167, s33, v135
    s_waitcnt vmcnt(7)
    v_dot2c_f32_bf16 v160, s32, v136
    v_dot2c_f32_bf16 v161, s33, v136
    v_dot2c_f32_bf16 v162, s32, v137
    v_dot2c_f32_bf16 v163, s33, v137
    v_dot2c_f32_bf16 v164, s32, v138
    v_dot2c_f32_bf16 v165, s33, v138
    v_dot2c_f32_bf16 v166, s32, v139
    v_dot2c_f32_bf16 v167, s33, v139
    s_waitcnt vmcnt(6)
    v_dot2c_f32_bf16 v160, s32, v140
    v_dot2c_f32_bf16 v161, s33, v140
    v_dot2c_f32_bf16 v162, s32, v141
    v_dot2c_f32_bf16 v163, s33, v141
    v_dot2c_f32_bf16 v164, s32, v142
    v_dot2c_f32_bf16 v165, s33, v142
    v_dot2c_f32_bf16 v166, s32, v143
    v_dot2c_f32_bf16 v167, s33, v143
    s_waitcnt vmcnt(5)
    v_dot2c_f32_bf16 v160, s32, v144
    v_dot2c_f32_bf16 v161, s33, v144
    v_dot2c_f32_bf16 v162, s32, v145
    v_dot2c_f32_bf16 v163, s33, v145
    v_dot2c_f32_bf16 v164, s32, v146
    v_dot2c_f32_bf16 v165, s33, v146
    v_dot2c_f32_bf16 v166, s32, v147
    v_dot2c_f32_bf16 v167, s33, v147
    s_waitcnt vmcnt(4)
    v_dot2c_f32_bf16 v160, s32, v148
    v_dot2c_f32_bf16 v161, s33, v148
    v_dot2c_f32_bf16 v162, s32, v149
    v_dot2c_f32_bf16 v163, s33, v149
    v_dot2c_f32_bf16 v164, s32, v150
    v_dot2c_f32_bf16 v165, s33, v150
    v_dot2c_f32_bf16 v166, s32, v151
    v_dot2c_f32_bf16 v167, s33, v151
    s_waitcnt vmcnt(3)
    v_dot2c_f32_bf16 v160, s32, v152
    v_dot2c_f32_bf16 v161, s33, v152
    v_dot2c_f32_bf16 v162, s32, v153
    v_dot2c_f32_bf16 v163, s33, v153
    v_dot2c_f32_bf16 v164, s32, v154
    v_dot2c_f32_bf16 v165, s33, v154
    v_dot2c_f32_bf16 v166, s32, v155
    v_dot2c_f32_bf16 v167, s33, v155
    s_waitcnt vmcnt(2)
    v_dot2c_f32_bf16 v160, s32, v156
    v_dot2c_f32_bf16 v161, s33, v156
    v_dot2c_f32_bf16 v162, s32, v157
    v_dot2c_f32_bf16 v163, s33, v157
    v_dot2c_f32_bf16 v164, s32, v158
    v_dot2c_f32_bf16 v165, s33, v158
    v_dot2c_f32_bf16 v166, s32, v159
    v_dot2c_f32_bf16 v167, s33, v159
    s_lshl_b32 s77, s92, 8
    s_nop 1
    v_fmac_f32 v32, s34, v160
    v_fmac_f32 v33, s34, v161
    v_fmac_f32 v34, s34, v162
    v_fmac_f32 v35, s34, v163
    v_fmac_f32 v36, s34, v164
    v_fmac_f32 v37, s34, v165
    v_fmac_f32 v38, s34, v166
    v_fmac_f32 v39, s34, v167
    s_nop 1
    v_permlane32_swap_b32 v32, v36
    v_permlane32_swap_b32 v33, v37
    v_permlane32_swap_b32 v34, v38
    v_permlane32_swap_b32 v35, v39
    s_cmp_lg_u32 s40, 0
    s_cbranch_scc1 L_rd_est
    buffer_store_dwordx4 v[32:35], v31, s[24:27], s77 offen
    buffer_store_dwordx4 v[36:39], v31, s[24:27], s77 offen offset:128
    s_waitcnt vmcnt(2)
    s_branch L_rd_last
L_rd_last0:
    s_waitcnt vmcnt(0)
L_rd_last:
    v_lshlrev_b32 v208, 16, v192
    v_and_b32 v209, s79, v192
    v_lshlrev_b32 v210, 16, v193
    v_and_b32 v211, s79, v193
    v_lshlrev_b32 v212, 16, v194
    v_and_b32 v213, s79, v194
    v_lshlrev_b32 v214, 16, v195
    v_and_b32 v215, s79, v195
    v_dot2c_f32_bf16 v208, s32, v196
    v_dot2c_f32_bf16 v209, s33, v196
    v_dot2c_f32_bf16 v210, s32, v197
    v_dot2c_f32_bf16 v211, s33, v197
    v_dot2c_f32_bf16 v212, s32, v198
    v_dot2c_f32_bf16 v213, s33, v198
    v_dot2c_f32_bf16 v214, s32, v199
    v_dot2c_f32_bf16 v215, s33, v199
    s_nop 2
    v_permlane32_swap_b32 v208, v212
    v_permlane32_swap_b32 v209, v213
    v_permlane32_swap_b32 v210, v214
    v_permlane32_swap_b32 v211, v215
    v_add_f32 v208, v208, v212
    v_add_f32 v209, v209, v213
    v_add_f32 v210, v210, v214
    v_add_f32 v211, v211, v215
    s_nop 1
    v_permlane16_swap_b32 v208, v210
    v_permlane16_swap_b32 v209, v211
    v_add_f32 v208, v208, v210
    v_add_f32 v209, v209, v211
    s_nop 1
    v_add_f32_dpp v208, v208, v208 row_ror:8 row_mask:0xf bank_mask:0xf
    v_add_f32_dpp v209, v209, v209 row_ror:8 row_mask:0xf bank_mask:0xf
    v_fmac_f32 v176, s34, v208
    v_fmac_f32 v177, s34, v209
    s_mov_b32 exec_lo, 0x00ff00ff
    s_mov_b32 exec_hi, 0x00ff00ff
    buffer_store_dwordx2 v[176:177], v187, s[24:27], 0 offen
    s_mov_b64 exec, -1
    s_branch L_fin
L_rd_est:
    buffer_store_dwordx4 v[32:35], v31, s[24:27], s77 offen sc1
    buffer_store_dwordx4 v[36:39], v31, s[24:27], s77 offen offset:128 sc1
    s_branch L_rd_np
L_fin:
L_end:
    s_endpgm
L_p2A_entry:
    v_mfma_f32_16x16x32_bf16 v[32:35], v[80:83], v[240:243], v[32:35]
    v_mfma_f32_16x16x32_bf16 v[40:43], v[80:83], v[244:247], v[40:43]
    v_mfma_f32_16x16x32_bf16 v[44:47], v[84:87], v[244:247], v[44:47]
    v_mfma_f32_16x16x32_bf16 v[36:39], v[84:87], v[240:243], v[36:39]
    s_waitcnt lgkmcnt(0)
    v_mfma_f32_16x16x32_bf16 v[48:51], v[88:91], v[248:251], v[32:35]
    v_mfma_f32_16x16x32_bf16 v[56:59], v[88:91], v[252:255], v[40:43]
    v_mfma_f32_16x16x32_bf16 v[60:63], v[92:95], v[252:255], v[44:47]
    v_mfma_f32_16x16x32_bf16 v[52:55], v[92:95], v[248:251], v[36:39]
    s_add_u32 s83, s82, s66
    s_add_u32 s82, s82, 49152
    s_cmp_ge_u32 s82, 147456
    s_cselect_b32 s82, 0, s82
    v_add_u32 v6, s82, v4
    v_add_u32 v7, s82, v5
    s_add_u32 s85, s85, 128
    s_nop 2
    v_cvt_pk_bf16_f32 v48, v48, v49
    v_cvt_pk_bf16_f32 v49, v50, v51
    v_cvt_pk_bf16_f32 v50, v52, v53
    v_cvt_pk_bf16_f32 v51, v54, v55
    s_add_u32 s75, s84, 0
    buffer_store_dwordx4 v[48:51], v13, s[20:23], s75 offen sc1
    v_cvt_pk_bf16_f32 v56, v56, v57
    v_cvt_pk_bf16_f32 v57, v58, v59
    v_cvt_pk_bf16_f32 v58, v60, v61
    v_cvt_pk_bf16_f32 v59, v62, v63
    s_add_u32 s75, s84, s89
    buffer_store_dwordx4 v[56:59], v13, s[20:23], s75 offen sc1
    s_add_u32 s84, s84, 16384
    s_waitcnt vmcnt(8)
.p2align 3
L_p2A:
    s_barrier
    ds_read_b64_tr_b16 v[64:65], v6 offset:0
    ds_read_b64_tr_b16 v[66:67], v6 offset:2048
    ds_read_b64_tr_b16 v[68:69], v7 offset:0
    ds_read_b64_tr_b16 v[70:71], v7 offset:2048
    ds_read_b64_tr_b16 v[72:73], v6 offset:4096
    ds_read_b64_tr_b16 v[74:75], v6 offset:6144
    ds_read_b64_tr_b16 v[76:77], v7 offset:4096
    ds_read_b64_tr_b16 v[78:79], v7 offset:6144
    ds_read_b64_tr_b16 v[80:81], v6 offset:8192
    ds_read_b64_tr_b16 v[82:83], v6 offset:10240
    ds_read_b64_tr_b16 v[84:85], v7 offset:8192
    ds_read_b64_tr_b16 v[86:87], v7 offset:10240
    s_waitcnt lgkmcnt(8)
    v_mfma_f32_16x16x32_bf16 v[32:35], v[64:67], v[160:163], 0
    ds_read_b64_tr_b16 v[88:89], v6 offset:12288
    v_mfma_f32_16x16x32_bf16 v[40:43], v[64:67], v[164:167], 0
    ds_read_b64_tr_b16 v[90:91], v6 offset:14336
    v_mfma_f32_16x16x32_bf16 v[44:47], v[68:71], v[164:167], 0
    ds_read_b64_tr_b16 v[92:93], v7 offset:12288
    v_mfma_f32_16x16x32_bf16 v[36:39], v[68:71], v[160:163], 0
    ds_read_b64_tr_b16 v[94:95], v7 offset:14336
    s_waitcnt lgkmcnt(8)
    v_mfma_f32_16x16x32_bf16 v[32:35], v[72:75], v[168:171], v[32:35]
    ds_read_b64_tr_b16 v[64:65], v6 offset:16384
    v_mfma_f32_16x16x32_bf16 v[40:43], v[72:75], v[172:175], v[40:43]
    ds_read_b64_tr_b16 v[66:67], v6 offset:18432
    v_mfma_f32_16x16x32_bf16 v[44:47], v[76:79], v[172:175], v[44:47]
    ds_read_b64_tr_b16 v[68:69], v7 offset:16384
    v_mfma_f32_16x16x32_bf16 v[36:39], v[76:79], v[168:171], v[36:39]
    ds_read_b64_tr_b16 v[70:71], v7 offset:18432
    s_waitcnt lgkmcnt(8)
    v_mfma_f32_16x16x32_bf16 v[32:35], v[80:83], v[176:179], v[32:35]
    ds_read_b64_tr_b16 v[72:73], v6 offset:20480
    v_mfma_f32_16x16x32_bf16 v[40:43], v[80:83], v[180:183], v[40:43]
    ds_read_b64_tr_b16 v[74:75], v6 offset:22528
    v_mfma_f32_16x16x32_bf16 v[44:47], v[84:87], v[180:183], v[44:47]
    ds_read_b64_tr_b16 v[76:77], v7 offset:20480
    v_mfma_f32_16x16x32_bf16 v[36:39], v[84:87], v[176:179], v[36:39]
    ds_read_b64_tr_b16 v[78:79], v7 offset:22528
    s_waitcnt lgkmcnt(8)
    v_mfma_f32_16x16x32_bf16 v[32:35], v[88:91], v[184:187], v[32:35]
    ds_read_b64_tr_b16 v[80:81], v6 offset:24576
    v_mfma_f32_16x16x32_bf16 v[40:43], v[88:91], v[188:191], v[40:43]
    ds_read_b64_tr_b16 v[82:83], v6 offset:26624
    v_mfma_f32_16x16x32_bf16 v[44:47], v[92:95], v[188:191], v[44:47]
    ds_read_b64_tr_b16 v[84:85], v7 offset:24576
    v_mfma_f32_16x16x32_bf16 v[36:39], v[92:95], v[184:187], v[36:39]
    ds_read_b64_tr_b16 v[86:87], v7 offset:26624
    s_waitcnt lgkmcnt(8)
    v_mfma_f32_16x16x32_bf16 v[32:35], v[64:67], v[192:195], v[32:35]
    ds_read_b64_tr_b16 v[88:89], v6 offset:28672
    v_mfma_f32_16x16x32_bf16 v[40:43], v[64:67], v[196:199], v[40:43]
    ds_read_b64_tr_b16 v[90:91], v6 offset:30720
    v_mfma_f32_16x16x32_bf16 v[44:47], v[68:71], v[196:199], v[44:47]
    ds_read_b64_tr_b16 v[92:93], v7 offset:28672
    v_mfma_f32_16x16x32_bf16 v[36:39], v[68:71], v[192:195], v[36:39]
    ds_read_b64_tr_b16 v[94:95], v7 offset:30720
    s_waitcnt lgkmcnt(8)
    v_mfma_f32_16x16x32_bf16 v[32:35], v[72:75], v[200:203], v[32:35]
    ds_read_b64_tr_b16 v[64:65], v6 offset:32768
    v_mfma_f32_16x16x32_bf16 v[40:43], v[72:75], v[204:207], v[40:43]
    ds_read_b64_tr_b16 v[66:67], v6 offset:34816
    v_mfma_f32_16x16x32_bf16 v[44:47], v[76:79], v[204:207], v[44:47]
    ds_read_b64_tr_b16 v[68:69], v7 offset:32768
    v_mfma_f32_16x16x32_bf16 v[36:39], v[76:79], v[200:203], v[36:39]
    ds_read_b64_tr_b16 v[70:71], v7 offset:34816
    s_waitcnt lgkmcnt(8)
    v_mfma_f32_16x16x32_bf16 v[32:35], v[80:83], v[208:211], v[32:35]
    ds_read_b64_tr_b16 v[72:73], v6 offset:36864
    v_mfma_f32_16x16x32_bf16 v[40:43], v[80:83], v[212:215], v[40:43]
    ds_read_b64_tr_b16 v[74:75], v6 offset:38912
    v_mfma_f32_16x16x32_bf16 v[44:47], v[84:87], v[212:215], v[44:47]
    ds_read_b64_tr_b16 v[76:77], v7 offset:36864
    v_mfma_f32_16x16x32_bf16 v[36:39], v[84:87], v[208:211], v[36:39]
    ds_read_b64_tr_b16 v[78:79], v7 offset:38912
    s_waitcnt lgkmcnt(8)
    v_mfma_f32_16x16x32_bf16 v[32:35], v[88:91], v[216:219], v[32:35]
    ds_read_b64_tr_b16 v[80:81], v6 offset:40960
    v_mfma_f32_16x16x32_bf16 v[40:43], v[88:91], v[220:223], v[40:43]
    ds_read_b64_tr_b16 v[82:83], v6 offset:43008
    v_mfma_f32_16x16x32_bf16 v[44:47], v[92:95], v[220:223], v[44:47]
    ds_read_b64_tr_b16 v[84:85], v7 offset:40960
    v_mfma_f32_16x16x32_bf16 v[36:39], v[92:95], v[216:219], v[36:39]
    ds_read_b64_tr_b16 v[86:87], v7 offset:43008
    s_waitcnt lgkmcnt(8)
    v_mfma_f32_16x16x32_bf16 v[32:35], v[64:67], v[224:227], v[32:35]
    ds_read_b64_tr_b16 v[88:89], v6 offset:45056
    v_mfma_f32_16x16x32_bf16 v[40:43], v[64:67], v[228:231], v[40:43]
    ds_read_b64_tr_b16 v[90:91], v6 offset:47104
    v_mfma_f32_16x16x32_bf16 v[44:47], v[68:71], v[228:231], v[44:47]
    ds_read_b64_tr_b16 v[92:93], v7 offset:45056
    v_mfma_f32_16x16x32_bf16 v[36:39], v[68:71], v[224:227], v[36:39]
    ds_read_b64_tr_b16 v[94:95], v7 offset:47104
    s_waitcnt lgkmcnt(8)
    v_mfma_f32_16x16x32_bf16 v[32:35], v[72:75], v[232:235], v[32:35]
    v_mfma_f32_16x16x32_bf16 v[40:43], v[72:75], v[236:239], v[40:43]
    v_mfma_f32_16x16x32_bf16 v[44:47], v[76:79], v[236:239], v[44:47]
    v_mfma_f32_16x16x32_bf16 v[36:39], v[76:79], v[232:235], v[36:39]
    s_waitcnt lgkmcnt(4)
    v_mfma_f32_16x16x32_bf16 v[32:35], v[80:83], v[240:243], v[32:35]
    v_mfma_f32_16x16x32_bf16 v[40:43], v[80:83], v[244:247], v[40:43]
    v_mfma_f32_16x16x32_bf16 v[44:47], v[84:87], v[244:247], v[44:47]
    v_mfma_f32_16x16x32_bf16 v[36:39], v[84:87], v[240:243], v[36:39]
    s_waitcnt lgkmcnt(0)
    v_mfma_f32_16x16x32_bf16 v[48:51], v[88:91], v[248:251], v[32:35]
    v_mfma_f32_16x16x32_bf16 v[56:59], v[88:91], v[252:255], v[40:43]
    v_mfma_f32_16x16x32_bf16 v[60:63], v[92:95], v[252:255], v[44:47]
    v_mfma_f32_16x16x32_bf16 v[52:55], v[92:95], v[248:251], v[36:39]
    s_nop 7
    v_cvt_pk_bf16_f32 v48, v48, v49
    v_cvt_pk_bf16_f32 v49, v50, v51
    v_cvt_pk_bf16_f32 v50, v52, v53
    v_cvt_pk_bf16_f32 v51, v54, v55
    s_add_u32 s75, s84, 0
    buffer_store_dwordx4 v[48:51], v13, s[20:23], s75 offen sc1
    v_cvt_pk_bf16_f32 v56, v56, v57
    v_cvt_pk_bf16_f32 v57, v58, v59
    v_cvt_pk_bf16_f32 v58, v60, v61
    v_cvt_pk_bf16_f32 v59, v62, v63
    s_add_u32 s75, s84, s89
    buffer_store_dwordx4 v[56:59], v13, s[20:23], s75 offen sc1
    s_add_u32 s84, s84, 16384
    s_cmp_le_u32 s78, 2
    s_cbranch_scc1 L_p2_ndA
    s_add_u32 m0, s83, 36864
    s_add_u32 s74, s85, 331776
    buffer_load_dwordx4 v3, s[16:19], s74 offen  lds
    s_add_u32 m0, s83, 40960
    s_add_u32 s74, s85, 368640
    buffer_load_dwordx4 v3, s[16:19], s74 offen  lds
    s_add_u32 m0, s83, 45056
    s_add_u32 s74, s85, 405504
    buffer_load_dwordx4 v3, s[16:19], s74 offen  lds
    s_waitcnt vmcnt(5)
    s_branch L_p2_ndA2
L_p2_ndA:
    s_waitcnt vmcnt(2)
L_p2_ndA2:
    s_cmp_lg_u32 s99, 1
    s_cbranch_scc1 L_p2_nh2
    s_add_u32 s76, s101, 8192
    buffer_load_dwordx4 v[128:131], v30, s[20:23], s76 offen offset:0 sc1
    buffer_load_dwordx4 v[132:135], v30, s[20:23], s76 offen offset:1024 sc1
    buffer_load_dwordx4 v[136:139], v30, s[20:23], s76 offen offset:2048 sc1
    buffer_load_dwordx4 v[140:143], v30, s[20:23], s76 offen offset:3072 sc1
    s_add_u32 s76, s101, 12288
    buffer_load_dwordx4 v[144:147], v30, s[20:23], s76 offen offset:0 sc1
    buffer_load_dwordx4 v[148:151], v30, s[20:23], s76 offen offset:1024 sc1
    buffer_load_dwordx4 v[152:155], v30, s[20:23], s76 offen offset:2048 sc1
    buffer_load_dwordx4 v[156:159], v30, s[20:23], s76 offen offset:3072 sc1
    s_mov_b32 s99, 0
L_p2_nh2:
    s_cmp_gt_i32 s78, s98
    s_cbranch_scc1 L_tp11
    v_cmp_ne_u32 vcc, 16, v28
    s_and_b64 vcc, vcc, 1
    s_cbranch_vccnz L_tp11
    s_add_u32 s76, s101, 0
    buffer_load_dwordx4 v[96:99], v30, s[20:23], s76 offen offset:0 sc1
    buffer_load_dwordx4 v[100:103], v30, s[20:23], s76 offen offset:1024 sc1
    buffer_load_dwordx4 v[104:107], v30, s[20:23], s76 offen offset:2048 sc1
    buffer_load_dwordx4 v[108:111], v30, s[20:23], s76 offen offset:3072 sc1
    s_add_u32 s76, s101, 4096
    buffer_load_dwordx4 v[112:115], v30, s[20:23], s76 offen offset:0 sc1
    buffer_load_dwordx4 v[116:119], v30, s[20:23], s76 offen offset:1024 sc1
    buffer_load_dwordx4 v[120:123], v30, s[20:23], s76 offen offset:2048 sc1
    buffer_load_dwordx4 v[124:127], v30, s[20:23], s76 offen offset:3072 sc1
    s_mov_b32 s98, -2
    s_mov_b32 s99, 1
L_tp11:
    s_sub_u32 s76, s78, 1
    s_cmp_gt_i32 s76, s98
    s_cbranch_scc1 L_fl12
    s_lshl_b32 s77, s92, 7
    s_add_u32 s77, s77, s100
    v_mov_b32 v28, 0
    s_mov_b64 exec, 1
    buffer_atomic_add v28, off, s[20:23], s77 sc0
    s_mov_b64 exec, -1
L_fl12:
    s_add_u32 s83, s82, s66
    s_add_u32 s82, s82, 49152
    s_cmp_ge_u32 s82, 147456
    s_cselect_b32 s82, 0, s82
    v_add_u32 v6, s82, v4
    v_add_u32 v7, s82, v5
    s_add_u32 s85, s85, 128
    s_sub_u32 s78, s78, 1
    s_cmp_lg_u32 s78, 0
    s_cbranch_scc1 L_p2A
    s_cmp_lg_u32 s99, 1
    s_cbranch_scc1 L_p2_done
    s_add_u32 s76, s101, 8192
    buffer_load_dwordx4 v[128:131], v30, s[20:23], s76 offen offset:0 sc1
    buffer_load_dwordx4 v[132:135], v30, s[20:23], s76 offen offset:1024 sc1
    buffer_load_dwordx4 v[136:139], v30, s[20:23], s76 offen offset:2048 sc1
    buffer_load_dwordx4 v[140:143], v30, s[20:23], s76 offen offset:3072 sc1
    s_add_u32 s76, s101, 12288
    buffer_load_dwordx4 v[144:147], v30, s[20:23], s76 offen offset:0 sc1
    buffer_load_dwordx4 v[148:151], v30, s[20:23], s76 offen offset:1024 sc1
    buffer_load_dwordx4 v[152:155], v30, s[20:23], s76 offen offset:2048 sc1
    buffer_load_dwordx4 v[156:159], v30, s[20:23], s76 offen offset:3072 sc1
    s_branch L_p2_done
L_ssm_main:
    v_mov_b32 v10, v19
    s_cmp_ge_u32 s93, 4
    s_cbranch_scc1 L_s_nw
    s_cmp_ge_u32 s93, 2
    s_cbranch_scc1 L_bw16
    s_waitcnt vmcnt(0)
L_bw16:
    s_waitcnt vmcnt(2)
L_s_nw:
    s_waitcnt lgkmcnt(0)
    s_barrier
    ds_read_b128 v[16:19], v4 offset:0
    ds_read_b128 v[112:115], v11 offset:0
    ds_read_b128 v[116:119], v11 offset:1024
    ds_read_b128 v[120:123], v11 offset:8192
    ds_read_b128 v[20:23], v4 offset:2048
    ds_read_b128 v[124:127], v11 offset:9216
    ds_read_b128 v[128:131], v11 offset:16384
    ds_read_b128 v[132:135], v11 offset:17408
    ds_read_b128 v[24:27], v5 offset:0
    ds_read_b128 v[136:139], v11 offset:24576
    ds_read_b128 v[28:31], v5 offset:2048
    ds_read_b128 v[140:143], v11 offset:25600
    s_waitcnt lgkmcnt(4)
    s_barrier
    v_mfma_f32_16x16x32_bf16 v[32:35], v[112:115], v[16:19], 0
    ds_read_b128 v[96:99], v4 offset:8192
    ds_read_b128 v[144:147], v11 offset:32768
    v_mfma_f32_16x16x32_bf16 v[36:39], v[116:119], v[16:19], 0
    ds_read_b128 v[100:103], v4 offset:10240
    ds_read_b128 v[148:151], v11 offset:33792
    v_mfma_f32_16x16x32_bf16 v[44:47], v[116:119], v[20:23], 0
    ds_read_b128 v[104:107], v5 offset:8192
    ds_read_b128 v[152:155], v11 offset:40960
    v_mfma_f32_16x16x32_bf16 v[40:43], v[112:115], v[20:23], 0
    s_add_u32 m0, s66, 24576
    s_add_u32 s74, s67, 384
    buffer_load_dwordx4 v2, s[12:15], s74 offen  lds
    s_waitcnt lgkmcnt(7)
    v_mfma_f32_16x16x32_bf16 v[32:35], v[120:123], v[24:27], v[32:35]
    ds_read_b128 v[108:111], v5 offset:10240
    v_mfma_f32_16x16x32_bf16 v[36:39], v[124:127], v[24:27], v[36:39]
    ds_read_b128 v[156:159], v11 offset:41984
    v_mfma_f32_16x16x32_bf16 v[44:47], v[124:127], v[28:31], v[44:47]
    ds_read_b128 v[16:19], v4 offset:16384
    ds_read_b128 v[160:163], v11 offset:49152
    v_mfma_f32_16x16x32_bf16 v[40:43], v[120:123], v[28:31], v[40:43]
    s_add_u32 m0, s66, 32768
    s_add_u32 s74, s67, 512
    buffer_load_dwordx4 v2, s[12:15], s74 offen  lds
    s_waitcnt lgkmcnt(7)
    v_mfma_f32_16x16x32_bf16 v[32:35], v[128:131], v[96:99], v[32:35]
    ds_read_b128 v[20:23], v4 offset:18432
    ds_read_b128 v[164:167], v11 offset:50176
    v_mfma_f32_16x16x32_bf16 v[36:39], v[132:135], v[96:99], v[36:39]
    ds_read_b128 v[24:27], v5 offset:16384
    ds_read_b128 v[168:171], v11 offset:57344
    v_mfma_f32_16x16x32_bf16 v[44:47], v[132:135], v[100:103], v[44:47]
    ds_read_b128 v[28:31], v5 offset:18432
    ds_read_b128 v[172:175], v11 offset:58368
    v_mfma_f32_16x16x32_bf16 v[40:43], v[128:131], v[100:103], v[40:43]
    s_add_u32 m0, s66, 40960
    s_add_u32 s74, s67, 640
    buffer_load_dwordx4 v2, s[12:15], s74 offen  lds
    s_waitcnt lgkmcnt(9)
    v_mfma_f32_16x16x32_bf16 v[32:35], v[136:139], v[104:107], v[32:35]
    v_mfma_f32_16x16x32_bf16 v[36:39], v[140:143], v[104:107], v[36:39]
    v_mfma_f32_16x16x32_bf16 v[44:47], v[140:143], v[108:111], v[44:47]
    v_mfma_f32_16x16x32_bf16 v[40:43], v[136:139], v[108:111], v[40:43]
    s_waitcnt vmcnt(0) lgkmcnt(0)
    s_barrier
    v_mfma_f32_16x16x32_bf16 v[32:35], v[144:147], v[16:19], v[32:35]
    ds_read_b128 v[96:99], v4 offset:24576
    v_mfma_f32_16x16x32_bf16 v[36:39], v[148:151], v[16:19], v[36:39]
    ds_read_b128 v[176:179], v10 offset:0
    v_mfma_f32_16x16x32_bf16 v[44:47], v[148:151], v[20:23], v[44:47]
    ds_read_b128 v[100:103], v4 offset:26624
    ds_read_b128 v[180:183], v10 offset:1024
    v_mfma_f32_16x16x32_bf16 v[40:43], v[144:147], v[20:23], v[40:43]
    s_add_u32 m0, s66, 49152
    s_add_u32 s74, s67, 768
    buffer_load_dwordx4 v2, s[12:15], s74 offen  lds
    v_mfma_f32_16x16x32_bf16 v[32:35], v[152:155], v[24:27], v[32:35]
    ds_read_b128 v[104:107], v5 offset:24576
    ds_read_b128 v[184:187], v10 offset:8192
    v_mfma_f32_16x16x32_bf16 v[36:39], v[156:159], v[24:27], v[36:39]
    ds_read_b128 v[188:191], v10 offset:9216
    v_mfma_f32_16x16x32_bf16 v[44:47], v[156:159], v[28:31], v[44:47]
    ds_read_b128 v[108:111], v5 offset:26624
    ds_read_b128 v[192:195], v10 offset:16384
    v_mfma_f32_16x16x32_bf16 v[40:43], v[152:155], v[28:31], v[40:43]
    s_add_u32 m0, s66, 57344
    s_add_u32 s74, s67, 896
    buffer_load_dwordx4 v2, s[12:15], s74 offen  lds
    s_waitcnt lgkmcnt(6)
    v_mfma_f32_16x16x32_bf16 v[32:35], v[160:163], v[96:99], v[32:35]
    ds_read_b128 v[16:19], v4 offset:32768
    v_mfma_f32_16x16x32_bf16 v[36:39], v[164:167], v[96:99], v[36:39]
    ds_read_b128 v[20:23], v4 offset:34816
    ds_read_b128 v[196:199], v10 offset:17408
    v_mfma_f32_16x16x32_bf16 v[44:47], v[164:167], v[100:103], v[44:47]
    ds_read_b128 v[24:27], v5 offset:32768
    ds_read_b128 v[200:203], v10 offset:24576
    v_mfma_f32_16x16x32_bf16 v[40:43], v[160:163], v[100:103], v[40:43]
    s_add_u32 m0, s66, 65536
    s_add_u32 s74, s67, 1024
    buffer_load_dwordx4 v2, s[12:15], s74 offen  lds
    s_waitcnt lgkmcnt(6)
    v_mfma_f32_16x16x32_bf16 v[32:35], v[168:171], v[104:107], v[32:35]
    ds_read_b128 v[28:31], v5 offset:34816
    ds_read_b128 v[204:207], v10 offset:25600
    v_mfma_f32_16x16x32_bf16 v[36:39], v[172:175], v[104:107], v[36:39]
    ds_read_b128 v[208:211], v10 offset:32768
    v_mfma_f32_16x16x32_bf16 v[44:47], v[172:175], v[108:111], v[44:47]
    ds_read_b128 v[96:99], v4 offset:40960
    ds_read_b128 v[212:215], v10 offset:33792
    v_mfma_f32_16x16x32_bf16 v[40:43], v[168:171], v[108:111], v[40:43]
    s_add_u32 m0, s66, 0
    s_add_u32 s74, s67, 36864
    buffer_load_dwordx4 v2, s[12:15], s74 offen  lds
    s_waitcnt lgkmcnt(8)
    v_mfma_f32_16x16x32_bf16 v[32:35], v[176:179], v[16:19], v[32:35]
    ds_read_b128 v[100:103], v4 offset:43008
    v_mfma_f32_16x16x32_bf16 v[36:39], v[180:183], v[16:19], v[36:39]
    ds_read_b128 v[104:107], v5 offset:40960
    s_add_u32 m0, s66, 8192
    s_add_u32 s74, s67, 36992
    buffer_load_dwordx4 v2, s[12:15], s74 offen  lds
    v_mfma_f32_16x16x32_bf16 v[44:47], v[180:183], v[20:23], v[44:47]
    ds_read_b128 v[108:111], v5 offset:43008
    v_mfma_f32_16x16x32_bf16 v[40:43], v[176:179], v[20:23], v[40:43]
    ds_write_b128 v12, v[240:243] offset:49152
    s_waitcnt lgkmcnt(8)
    v_mfma_f32_16x16x32_bf16 v[32:35], v[184:187], v[24:27], v[32:35]
    v_mfma_f32_16x16x32_bf16 v[36:39], v[188:191], v[24:27], v[36:39]
    ds_write_b128 v12, v[248:251] offset:57344
    v_mfma_f32_16x16x32_bf16 v[44:47], v[188:191], v[28:31], v[44:47]
    v_mfma_f32_16x16x32_bf16 v[40:43], v[184:187], v[28:31], v[40:43]
    s_add_u32 m0, s66, 16384
    s_add_u32 s74, s67, 37120
    buffer_load_dwordx4 v2, s[12:15], s74 offen  lds
    s_waitcnt vmcnt(3) lgkmcnt(0)
    s_barrier
    s_lshl_b32 s75, s6, 4
    s_add_u32 s75, s75, s7
    s_cmp_eq_u32 s93, 0
    s_cselect_b32 s75, s75, 256
    s_mul_i32 s76, s6, s81
    s_cmp_eq_u32 s76, 0
    s_cselect_b32 s75, s75, 256
    v_mov_b32 v94, 0
    v_mov_b32 v95, 1
    s_mov_b64 exec, 1
    buffer_store_byte v95, v94, s[28:31], s75 offen sc1
    s_mov_b64 exec, -1
    v_mfma_f32_16x16x32_bf16 v[32:35], v[192:195], v[96:99], v[32:35]
    ds_read_b128 v[16:19], v6 offset:0
    ds_read_b128 v[216:219], v10 offset:40960
    v_mfma_f32_16x16x32_bf16 v[36:39], v[196:199], v[96:99], v[36:39]
    ds_read_b128 v[220:223], v10 offset:41984
    v_mfma_f32_16x16x32_bf16 v[44:47], v[196:199], v[100:103], v[44:47]
    ds_read_b128 v[20:23], v6 offset:2048
    ds_read_b128 v[224:227], v10 offset:49152
    v_mfma_f32_16x16x32_bf16 v[40:43], v[192:195], v[100:103], v[40:43]
    s_add_u32 m0, s66, 24576
    s_add_u32 s74, s67, 37248
    buffer_load_dwordx4 v2, s[12:15], s74 offen  lds
    v_mfma_f32_16x16x32_bf16 v[32:35], v[200:203], v[104:107], v[32:35]
    ds_read_b128 v[24:27], v7 offset:0
    ds_read_b128 v[228:231], v10 offset:50176
    v_mfma_f32_16x16x32_bf16 v[36:39], v[204:207], v[104:107], v[36:39]
    ds_read_b128 v[232:235], v10 offset:57344
    v_mfma_f32_16x16x32_bf16 v[44:47], v[204:207], v[108:111], v[44:47]
    ds_read_b128 v[28:31], v7 offset:2048
    ds_read_b128 v[236:239], v10 offset:58368
    v_mfma_f32_16x16x32_bf16 v[40:43], v[200:203], v[108:111], v[40:43]
    s_add_u32 m0, s66, 32768
    s_add_u32 s74, s67, 37376
    buffer_load_dwordx4 v2, s[12:15], s74 offen  lds
    s_waitcnt lgkmcnt(6)
    v_mfma_f32_16x16x32_bf16 v[32:35], v[208:211], v[16:19], v[32:35]
    ds_read_b128 v[96:99], v6 offset:8192
    ds_read_b128 v[240:243], v11 offset:49152
    v_mfma_f32_16x16x32_bf16 v[36:39], v[212:215], v[16:19], v[36:39]
    ds_read_b128 v[100:103], v6 offset:10240
    ds_read_b128 v[244:247], v11 offset:50176
    v_mfma_f32_16x16x32_bf16 v[44:47], v[212:215], v[20:23], v[44:47]
    ds_read_b128 v[104:107], v7 offset:8192
    ds_read_b128 v[248:251], v11 offset:57344
    v_mfma_f32_16x16x32_bf16 v[40:43], v[208:211], v[20:23], v[40:43]
    ds_read_b128 v[252:255], v11 offset:58368
    s_add_u32 m0, s66, 40960
    s_add_u32 s74, s67, 37504
    buffer_load_dwordx4 v2, s[12:15], s74 offen  lds
    s_waitcnt lgkmcnt(8)
    v_mfma_f32_16x16x32_bf16 v[32:35], v[216:219], v[24:27], v[32:35]
    ds_read_b128 v[108:111], v7 offset:10240
    v_mfma_f32_16x16x32_bf16 v[36:39], v[220:223], v[24:27], v[36:39]
    v_mfma_f32_16x16x32_bf16 v[44:47], v[220:223], v[28:31], v[44:47]
    ds_read_b128 v[16:19], v6 offset:16384
    v_mfma_f32_16x16x32_bf16 v[40:43], v[216:219], v[28:31], v[40:43]
    s_waitcnt lgkmcnt(6)
    v_mfma_f32_16x16x32_bf16 v[32:35], v[224:227], v[96:99], v[32:35]
    ds_read_b128 v[20:23], v6 offset:18432
    v_mfma_f32_16x16x32_bf16 v[36:39], v[228:231], v[96:99], v[36:39]
    ds_read_b128 v[24:27], v7 offset:16384
    v_mfma_f32_16x16x32_bf16 v[44:47], v[228:231], v[100:103], v[44:47]
    ds_read_b128 v[28:31], v7 offset:18432
    v_mfma_f32_16x16x32_bf16 v[40:43], v[224:227], v[100:103], v[40:43]
    s_waitcnt lgkmcnt(4)
    v_mfma_f32_16x16x32_bf16 v[32:35], v[232:235], v[104:107], v[32:35]
    v_mfma_f32_16x16x32_bf16 v[36:39], v[236:239], v[104:107], v[36:39]
    v_mfma_f32_16x16x32_bf16 v[44:47], v[236:239], v[108:111], v[44:47]
    v_mfma_f32_16x16x32_bf16 v[40:43], v[232:235], v[108:111], v[40:43]
    s_cmp_ge_u32 s93, 4
    s_cbranch_scc1 L_s_nbt
    s_and_b32 s75, s3, 1
    s_mul_i32 s75, s75, 45
    s_mul_i32 s76, s87, 90
    s_add_u32 s75, s75, s76
    s_add_u32 s75, s75, 576
    v_add_lshl_u32 v92, v1, s75, 7
    s_mov_b32 exec_hi, 0x1fff
    buffer_load_dword v93, v92, s[12:15], s67 offen
    s_mov_b32 exec_hi, -1
L_s_nbt:
    s_waitcnt vmcnt(3) lgkmcnt(0)
    s_barrier
    s_cmp_lt_u32 s93, 4
    s_cbranch_scc1 L_s_nd3
    s_add_u32 m0, s66, 45056
    s_add_u32 s74, s67, 19200
    buffer_load_dwordx4 v2, s[12:15], s74 offen  lds
    s_add_u32 m0, s66, 49152
    s_add_u32 s74, s67, 37632
    buffer_load_dwordx4 v2, s[12:15], s74 offen  lds
    s_add_u32 m0, s66, 53248
    s_add_u32 s74, s67, 19328
    buffer_load_dwordx4 v2, s[12:15], s74 offen  lds
    s_add_u32 m0, s66, 57344
    s_add_u32 s74, s67, 37760
    buffer_load_dwordx4 v2, s[12:15], s74 offen  lds
    s_add_u32 m0, s66, 61440
    s_add_u32 s74, s67, 19456
    buffer_load_dwordx4 v2, s[12:15], s74 offen  lds
    s_add_u32 m0, s66, 65536
    s_add_u32 s74, s67, 37888
    buffer_load_dwordx4 v2, s[12:15], s74 offen  lds
L_s_nd3:
    v_mfma_f32_16x16x32_bf16 v[32:35], v[240:243], v[16:19], v[32:35]
    ds_read_b128 v[96:99], v4 offset:0
    v_mfma_f32_16x16x32_bf16 v[36:39], v[244:247], v[16:19], v[36:39]
    v_mfma_f32_16x16x32_bf16 v[44:47], v[244:247], v[20:23], v[44:47]
    ds_read_b128 v[100:103], v4 offset:2048
    v_mfma_f32_16x16x32_bf16 v[40:43], v[240:243], v[20:23], v[40:43]
    v_mfma_f32_16x16x32_bf16 v[32:35], v[248:251], v[24:27], v[32:35]
    ds_read_b128 v[104:107], v5 offset:0
    v_mfma_f32_16x16x32_bf16 v[36:39], v[252:255], v[24:27], v[36:39]
    v_mfma_f32_16x16x32_bf16 v[44:47], v[252:255], v[28:31], v[44:47]
    ds_read_b128 v[108:111], v5 offset:2048
    v_mfma_f32_16x16x32_bf16 v[40:43], v[248:251], v[28:31], v[40:43]
    s_waitcnt lgkmcnt(2)
    v_mfma_f32_16x16x32_bf16 v[48:51], v[112:115], v[96:99], 0
    ds_read_b128 v[16:19], v4 offset:8192
    v_mfma_f32_16x16x32_bf16 v[52:55], v[116:119], v[96:99], 0
    ds_read_b128 v[20:23], v4 offset:10240
    v_mfma_f32_16x16x32_bf16 v[60:63], v[116:119], v[100:103], 0
    ds_read_b128 v[24:27], v5 offset:8192
    v_mfma_f32_16x16x32_bf16 v[56:59], v[112:115], v[100:103], 0
    s_waitcnt lgkmcnt(3)
    v_mfma_f32_16x16x32_bf16 v[48:51], v[120:123], v[104:107], v[48:51]
    ds_read_b128 v[28:31], v5 offset:10240
    v_mfma_f32_16x16x32_bf16 v[52:55], v[124:127], v[104:107], v[52:55]
    v_mfma_f32_16x16x32_bf16 v[60:63], v[124:127], v[108:111], v[60:63]
    ds_read_b128 v[96:99], v4 offset:16384
    v_mfma_f32_16x16x32_bf16 v[56:59], v[120:123], v[108:111], v[56:59]
    s_waitcnt lgkmcnt(3)
    v_mfma_f32_16x16x32_bf16 v[48:51], v[128:131], v[16:19], v[48:51]
    ds_read_b128 v[100:103], v4 offset:18432
    v_mfma_f32_16x16x32_bf16 v[52:55], v[132:135], v[16:19], v[52:55]
    ds_read_b128 v[104:107], v5 offset:16384
    v_mfma_f32_16x16x32_bf16 v[60:63], v[132:135], v[20:23], v[60:63]
    ds_read_b128 v[108:111], v5 offset:18432
    v_mfma_f32_16x16x32_bf16 v[56:59], v[128:131], v[20:23], v[56:59]
    s_waitcnt lgkmcnt(4)
    v_mfma_f32_16x16x32_bf16 v[48:51], v[136:139], v[24:27], v[48:51]
    v_mfma_f32_16x16x32_bf16 v[52:55], v[140:143], v[24:27], v[52:55]
    v_mfma_f32_16x16x32_bf16 v[60:63], v[140:143], v[28:31], v[60:63]
    v_mfma_f32_16x16x32_bf16 v[56:59], v[136:139], v[28:31], v[56:59]
    s_cmp_ge_u32 s93, 4
    s_cbranch_scc1 L_s_w4
    s_waitcnt vmcnt(1)
L_s_w4:
    s_waitcnt vmcnt(6) lgkmcnt(0)
    s_barrier
    s_cmp_lt_u32 s93, 4
    s_cbranch_scc1 L_s_nd4
    s_add_u32 m0, s66, -4096
    s_add_u32 s74, s67, 55296
    buffer_load_dwordx4 v2, s[12:15], s74 offen  lds
    s_add_u32 m0, s66, 0
    s_add_u32 s74, s67, 73728
    buffer_load_dwordx4 v2, s[12:15], s74 offen  lds
    s_add_u32 m0, s66, 4096
    s_add_u32 s74, s67, 55424
    buffer_load_dwordx4 v2, s[12:15], s74 offen  lds
    s_add_u32 m0, s66, 8192
    s_add_u32 s74, s67, 73856
    buffer_load_dwordx4 v2, s[12:15], s74 offen  lds
    s_add_u32 m0, s66, 12288
    s_add_u32 s74, s67, 55552
    buffer_load_dwordx4 v2, s[12:15], s74 offen  lds
    s_add_u32 m0, s66, 16384
    s_add_u32 s74, s67, 73984
    buffer_load_dwordx4 v2, s[12:15], s74 offen  lds
    v_lshlrev_b32 v3, 16, v3
    v_lshlrev_b32 v8, 16, v8
    v_lshlrev_b32 v9, 16, v9
    v_mul_f32 v88, 0x3fb8aa3b, v3
    v_exp_f32 v88, v88
    s_nop 0
    v_cvt_pk_bf16_f32 v88, v88, v88
    v_and_b32 v88, s79, v88
    v_mul_f32 v89, v88, v8
    v_mul_f32 v90, v88, v9
    v_mul_f32 v89, 0x3fb8aa3b, v89
    v_exp_f32 v89, v89
    v_mul_f32 v90, 0.15915494, v90
    v_rndne_f32 v91, v90
    v_sub_f32 v90, v90, v91
    v_cos_f32 v80, v90
    v_sin_f32 v81, v90
    s_nop 0
    v_mul_f32 v80, v80, v89
    v_mul_f32 v81, v81, v89
    v_mul_f32 v91, v8, v8
    v_fmac_f32 v91, v9, v9
    v_rcp_f32 v91, v91
    v_add_f32 v89, -1.0, v80
    v_mul_f32 v91, 0x3f6ff558, v91
    v_mul_f32 v82, v89, v8
    v_fmac_f32 v82, v81, v9
    v_mul_f32 v83, v81, v8
    v_fma_f32 v83, -v89, v9, v83
    v_mul_f32 v82, v82, v91
    v_mul_f32 v83, v83, v91
    v_mul_f32 v89, v81, v81
    v_mul_f32 v90, v80, v81
    v_fma_f32 v84, v80, v80, -v89
    v_add_f32 v85, v90, v90
    v_mul_f32 v89, v85, v85
    v_mul_f32 v90, v84, v85
    v_fma_f32 v84, v84, v84, -v89
    v_add_f32 v85, v90, v90
    v_mul_f32 v89, v85, v85
    v_mul_f32 v90, v84, v85
    v_fma_f32 v84, v84, v84, -v89
    v_add_f32 v85, v90, v90
    v_mul_f32 v89, v85, v85
    v_mul_f32 v90, v84, v85
    v_fma_f32 v86, v84, v84, -v89
    v_add_f32 v87, v90, v90
    v_mul_f32 v89, v87, v87
    v_mul_f32 v90, v86, v87
    v_fma_f32 v86, v86, v86, -v89
    v_add_f32 v87, v90, v90
    v_mul_f32 v89, v87, v87
    v_mul_f32 v90, v86, v87
    v_fma_f32 v86, v86, v86, -v89
    v_add_f32 v87, v90, v90
    v_mul_f32 v89, v87, v87
    v_mul_f32 v90, v86, v87
    v_fma_f32 v86, v86, v86, -v89
    v_add_f32 v87, v90, v90
    v_subrev_u32 v89, 256, v0
    v_min_u32 v89, 143, v89
    v_lshlrev_b32 v89, 5, v89
    v_add_u32 v89, 158208, v89
    ds_write_b128 v89, v[80:83]
    ds_write_b128 v89, v[84:87] offset:16
L_s_nd4:
    v_mfma_f32_16x16x32_bf16 v[48:51], v[144:147], v[96:99], v[48:51]
    ds_read_b128 v[16:19], v4 offset:24576
    v_mfma_f32_16x16x32_bf16 v[52:55], v[148:151], v[96:99], v[52:55]
    v_mfma_f32_16x16x32_bf16 v[60:63], v[148:151], v[100:103], v[60:63]
    ds_read_b128 v[20:23], v4 offset:26624
    v_mfma_f32_16x16x32_bf16 v[56:59], v[144:147], v[100:103], v[56:59]
    v_mfma_f32_16x16x32_bf16 v[48:51], v[152:155], v[104:107], v[48:51]
    ds_read_b128 v[24:27], v5 offset:24576
    v_mfma_f32_16x16x32_bf16 v[52:55], v[156:159], v[104:107], v[52:55]
    v_mfma_f32_16x16x32_bf16 v[60:63], v[156:159], v[108:111], v[60:63]
    ds_read_b128 v[28:31], v5 offset:26624
    v_mfma_f32_16x16x32_bf16 v[56:59], v[152:155], v[108:111], v[56:59]
    s_waitcnt lgkmcnt(2)
    v_mfma_f32_16x16x32_bf16 v[48:51], v[160:163], v[16:19], v[48:51]
    ds_read_b128 v[96:99], v4 offset:32768
    v_mfma_f32_16x16x32_bf16 v[52:55], v[164:167], v[16:19], v[52:55]
    ds_read_b128 v[100:103], v4 offset:34816
    v_mfma_f32_16x16x32_bf16 v[60:63], v[164:167], v[20:23], v[60:63]
    ds_read_b128 v[104:107], v5 offset:32768
    v_mfma_f32_16x16x32_bf16 v[56:59], v[160:163], v[20:23], v[56:59]
    s_waitcnt lgkmcnt(3)
    v_mfma_f32_16x16x32_bf16 v[48:51], v[168:171], v[24:27], v[48:51]
    ds_read_b128 v[108:111], v5 offset:34816
    v_mfma_f32_16x16x32_bf16 v[52:55], v[172:175], v[24:27], v[52:55]
    v_mfma_f32_16x16x32_bf16 v[60:63], v[172:175], v[28:31], v[60:63]
    ds_read_b128 v[16:19], v4 offset:40960
    v_mfma_f32_16x16x32_bf16 v[56:59], v[168:171], v[28:31], v[56:59]
    s_waitcnt lgkmcnt(3)
    v_mfma_f32_16x16x32_bf16 v[48:51], v[176:179], v[96:99], v[48:51]
    ds_read_b128 v[20:23], v4 offset:43008
    v_mfma_f32_16x16x32_bf16 v[52:55], v[180:183], v[96:99], v[52:55]
    ds_read_b128 v[24:27], v5 offset:40960
    v_mfma_f32_16x16x32_bf16 v[60:63], v[180:183], v[100:103], v[60:63]
    ds_read_b128 v[28:31], v5 offset:43008
    v_mfma_f32_16x16x32_bf16 v[56:59], v[176:179], v[100:103], v[56:59]
    s_waitcnt lgkmcnt(4)
    v_mfma_f32_16x16x32_bf16 v[48:51], v[184:187], v[104:107], v[48:51]
    v_mfma_f32_16x16x32_bf16 v[52:55], v[188:191], v[104:107], v[52:55]
    v_mfma_f32_16x16x32_bf16 v[60:63], v[188:191], v[108:111], v[60:63]
    v_mfma_f32_16x16x32_bf16 v[56:59], v[184:187], v[108:111], v[56:59]
    s_waitcnt vmcnt(6) lgkmcnt(0)
    s_barrier
    s_cmp_lt_u32 s93, 4
    s_cbranch_scc1 L_s_nd5
    s_add_u32 m0, s66, 20480
    s_add_u32 s74, s67, 55680
    buffer_load_dwordx4 v2, s[12:15], s74 offen  lds
    s_add_u32 m0, s66, 24576
    s_add_u32 s74, s67, 74112
    buffer_load_dwordx4 v2, s[12:15], s74 offen  lds
    s_add_u32 m0, s66, 28672
    s_add_u32 s74, s67, 55808
    buffer_load_dwordx4 v2, s[12:15], s74 offen  lds
    s_add_u32 m0, s66, 32768
    s_add_u32 s74, s67, 74240
    buffer_load_dwordx4 v2, s[12:15], s74 offen  lds
    s_add_u32 m0, s66, 36864
    s_add_u32 s74, s67, 55936
    buffer_load_dwordx4 v2, s[12:15], s74 offen  lds
    s_add_u32 m0, s66, 40960
    s_add_u32 s74, s67, 74368
    buffer_load_dwordx4 v2, s[12:15], s74 offen  lds
L_s_nd5:
    v_mfma_f32_16x16x32_bf16 v[48:51], v[192:195], v[16:19], v[48:51]
    ds_read_b128 v[96:99], v6 offset:0
    v_mfma_f32_16x16x32_bf16 v[52:55], v[196:199], v[16:19], v[52:55]
    v_mfma_f32_16x16x32_bf16 v[60:63], v[196:199], v[20:23], v[60:63]
    ds_read_b128 v[100:103], v6 offset:2048
    v_mfma_f32_16x16x32_bf16 v[56:59], v[192:195], v[20:23], v[56:59]
    v_mfma_f32_16x16x32_bf16 v[48:51], v[200:203], v[24:27], v[48:51]
    ds_read_b128 v[104:107], v7 offset:0
    v_mfma_f32_16x16x32_bf16 v[52:55], v[204:207], v[24:27], v[52:55]
    v_mfma_f32_16x16x32_bf16 v[60:63], v[204:207], v[28:31], v[60:63]
    ds_read_b128 v[108:111], v7 offset:2048
    v_mfma_f32_16x16x32_bf16 v[56:59], v[200:203], v[28:31], v[56:59]
    s_waitcnt lgkmcnt(2)
    v_mfma_f32_16x16x32_bf16 v[48:51], v[208:211], v[96:99], v[48:51]
    ds_read_b128 v[16:19], v6 offset:8192
    v_mfma_f32_16x16x32_bf16 v[52:55], v[212:215], v[96:99], v[52:55]
    ds_read_b128 v[20:23], v6 offset:10240
    v_mfma_f32_16x16x32_bf16 v[60:63], v[212:215], v[100:103], v[60:63]
    ds_read_b128 v[24:27], v7 offset:8192
    v_mfma_f32_16x16x32_bf16 v[56:59], v[208:211], v[100:103], v[56:59]
    s_waitcnt lgkmcnt(3)
    v_mfma_f32_16x16x32_bf16 v[48:51], v[216:219], v[104:107], v[48:51]
    ds_read_b128 v[28:31], v7 offset:10240
    v_mfma_f32_16x16x32_bf16 v[52:55], v[220:223], v[104:107], v[52:55]
    v_mfma_f32_16x16x32_bf16 v[60:63], v[220:223], v[108:111], v[60:63]
    ds_read_b128 v[96:99], v6 offset:16384
    v_mfma_f32_16x16x32_bf16 v[56:59], v[216:219], v[108:111], v[56:59]
    s_waitcnt lgkmcnt(3)
    v_mfma_f32_16x16x32_bf16 v[48:51], v[224:227], v[16:19], v[48:51]
    ds_read_b128 v[100:103], v6 offset:18432
    v_mfma_f32_16x16x32_bf16 v[52:55], v[228:231], v[16:19], v[52:55]
    ds_read_b128 v[104:107], v7 offset:16384
    v_mfma_f32_16x16x32_bf16 v[60:63], v[228:231], v[20:23], v[60:63]
    ds_read_b128 v[108:111], v7 offset:18432
    v_mfma_f32_16x16x32_bf16 v[56:59], v[224:227], v[20:23], v[56:59]
    s_waitcnt lgkmcnt(4)
    v_mfma_f32_16x16x32_bf16 v[48:51], v[232:235], v[24:27], v[48:51]
    v_mfma_f32_16x16x32_bf16 v[52:55], v[236:239], v[24:27], v[52:55]
    v_mfma_f32_16x16x32_bf16 v[60:63], v[236:239], v[28:31], v[60:63]
    v_mfma_f32_16x16x32_bf16 v[56:59], v[232:235], v[28:31], v[56:59]
    s_waitcnt vmcnt(6) lgkmcnt(0)
    s_barrier
    s_cmp_lt_u32 s93, 4
    s_cbranch_scc1 L_s_nd6
    s_add_u32 m0, s66, 45056
    s_add_u32 s74, s67, 56064
    buffer_load_dwordx4 v2, s[12:15], s74 offen  lds
    s_add_u32 m0, s66, 49152
    s_add_u32 s74, s67, 74496
    buffer_load_dwordx4 v2, s[12:15], s74 offen  lds
    s_add_u32 m0, s66, 53248
    s_add_u32 s74, s67, 56192
    buffer_load_dwordx4 v2, s[12:15], s74 offen  lds
    s_add_u32 m0, s66, 57344
    s_add_u32 s74, s67, 74624
    buffer_load_dwordx4 v2, s[12:15], s74 offen  lds
    s_add_u32 m0, s66, 61440
    s_add_u32 s74, s67, 56320
    buffer_load_dwordx4 v2, s[12:15], s74 offen  lds
    s_add_u32 m0, s66, 65536
    s_add_u32 s74, s67, 74752
    buffer_load_dwordx4 v2, s[12:15], s74 offen  lds
L_s_nd6:
    v_mfma_f32_16x16x32_bf16 v[48:51], v[240:243], v[96:99], v[48:51]
    ds_read_b128 v[16:19], v4 offset:0
    v_mfma_f32_16x16x32_bf16 v[52:55], v[244:247], v[96:99], v[52:55]
    v_mfma_f32_16x16x32_bf16 v[60:63], v[244:247], v[100:103], v[60:63]
    ds_read_b128 v[20:23], v4 offset:2048
    v_mfma_f32_16x16x32_bf16 v[56:59], v[240:243], v[100:103], v[56:59]
    v_mfma_f32_16x16x32_bf16 v[48:51], v[248:251], v[104:107], v[48:51]
    ds_read_b128 v[24:27], v5 offset:0
    v_mfma_f32_16x16x32_bf16 v[52:55], v[252:255], v[104:107], v[52:55]
    v_mfma_f32_16x16x32_bf16 v[60:63], v[252:255], v[108:111], v[60:63]
    ds_read_b128 v[28:31], v5 offset:2048
    v_mfma_f32_16x16x32_bf16 v[56:59], v[248:251], v[108:111], v[56:59]
    s_waitcnt lgkmcnt(2)
    v_mfma_f32_16x16x32_bf16 v[64:67], v[112:115], v[16:19], 0
    ds_read_b128 v[96:99], v4 offset:8192
    v_mfma_f32_16x16x32_bf16 v[68:71], v[116:119], v[16:19], 0
    ds_read_b128 v[100:103], v4 offset:10240
    v_mfma_f32_16x16x32_bf16 v[76:79], v[116:119], v[20:23], 0
    ds_read_b128 v[104:107], v5 offset:8192
    v_mfma_f32_16x16x32_bf16 v[72:75], v[112:115], v[20:23], 0
    s_waitcnt lgkmcnt(3)
    v_mfma_f32_16x16x32_bf16 v[64:67], v[120:123], v[24:27], v[64:67]
    ds_read_b128 v[108:111], v5 offset:10240
    v_mfma_f32_16x16x32_bf16 v[68:71], v[124:127], v[24:27], v[68:71]
    v_mfma_f32_16x16x32_bf16 v[76:79], v[124:127], v[28:31], v[76:79]
    ds_read_b128 v[16:19], v4 offset:16384
    v_mfma_f32_16x16x32_bf16 v[72:75], v[120:123], v[28:31], v[72:75]
    s_waitcnt lgkmcnt(3)
    v_mfma_f32_16x16x32_bf16 v[64:67], v[128:131], v[96:99], v[64:67]
    ds_read_b128 v[20:23], v4 offset:18432
    v_mfma_f32_16x16x32_bf16 v[68:71], v[132:135], v[96:99], v[68:71]
    ds_read_b128 v[24:27], v5 offset:16384
    v_mfma_f32_16x16x32_bf16 v[76:79], v[132:135], v[100:103], v[76:79]
    ds_read_b128 v[28:31], v5 offset:18432
    v_mfma_f32_16x16x32_bf16 v[72:75], v[128:131], v[100:103], v[72:75]
    s_waitcnt lgkmcnt(4)
    v_mfma_f32_16x16x32_bf16 v[64:67], v[136:139], v[104:107], v[64:67]
    v_mfma_f32_16x16x32_bf16 v[68:71], v[140:143], v[104:107], v[68:71]
    v_mfma_f32_16x16x32_bf16 v[76:79], v[140:143], v[108:111], v[76:79]
    v_mfma_f32_16x16x32_bf16 v[72:75], v[136:139], v[108:111], v[72:75]
    s_waitcnt vmcnt(6) lgkmcnt(0)
    s_barrier
    s_cmp_lt_u32 s93, 4
    s_cbranch_scc1 L_s_nd7
    s_add_u32 m0, s66, -4096
    s_add_u32 s74, s67, 92160
    buffer_load_dwordx4 v2, s[12:15], s74 offen  lds
    s_add_u32 m0, s66, 0
    s_add_u32 s74, s67, 110592
    buffer_load_dwordx4 v2, s[12:15], s74 offen  lds
    s_add_u32 m0, s66, 4096
    s_add_u32 s74, s67, 92288
    buffer_load_dwordx4 v2, s[12:15], s74 offen  lds
    s_add_u32 m0, s66, 8192
    s_add_u32 s74, s67, 110720
    buffer_load_dwordx4 v2, s[12:15], s74 offen  lds
    s_add_u32 m0, s66, 12288
    s_add_u32 s74, s67, 92416
    buffer_load_dwordx4 v2, s[12:15], s74 offen  lds
    s_add_u32 m0, s66, 16384
    s_add_u32 s74, s67, 110848
    buffer_load_dwordx4 v2, s[12:15], s74 offen  lds
L_s_nd7:
    v_mfma_f32_16x16x32_bf16 v[64:67], v[144:147], v[16:19], v[64:67]
    ds_read_b128 v[96:99], v4 offset:24576
    v_mfma_f32_16x16x32_bf16 v[68:71], v[148:151], v[16:19], v[68:71]
    v_mfma_f32_16x16x32_bf16 v[76:79], v[148:151], v[20:23], v[76:79]
    ds_read_b128 v[100:103], v4 offset:26624
    v_mfma_f32_16x16x32_bf16 v[72:75], v[144:147], v[20:23], v[72:75]
    v_mfma_f32_16x16x32_bf16 v[64:67], v[152:155], v[24:27], v[64:67]
    ds_read_b128 v[104:107], v5 offset:24576
    v_mfma_f32_16x16x32_bf16 v[68:71], v[156:159], v[24:27], v[68:71]
    v_mfma_f32_16x16x32_bf16 v[76:79], v[156:159], v[28:31], v[76:79]
    ds_read_b128 v[108:111], v5 offset:26624
    v_mfma_f32_16x16x32_bf16 v[72:75], v[152:155], v[28:31], v[72:75]
    s_waitcnt lgkmcnt(2)
    v_mfma_f32_16x16x32_bf16 v[64:67], v[160:163], v[96:99], v[64:67]
    ds_read_b128 v[16:19], v4 offset:32768
    v_mfma_f32_16x16x32_bf16 v[68:71], v[164:167], v[96:99], v[68:71]
    ds_read_b128 v[20:23], v4 offset:34816
    v_mfma_f32_16x16x32_bf16 v[76:79], v[164:167], v[100:103], v[76:79]
    ds_read_b128 v[24:27], v5 offset:32768
    v_mfma_f32_16x16x32_bf16 v[72:75], v[160:163], v[100:103], v[72:75]
    s_waitcnt lgkmcnt(3)
    v_mfma_f32_16x16x32_bf16 v[64:67], v[168:171], v[104:107], v[64:67]
    ds_read_b128 v[28:31], v5 offset:34816
    v_mfma_f32_16x16x32_bf16 v[68:71], v[172:175], v[104:107], v[68:71]
    v_mfma_f32_16x16x32_bf16 v[76:79], v[172:175], v[108:111], v[76:79]
    ds_read_b128 v[96:99], v4 offset:40960
    v_mfma_f32_16x16x32_bf16 v[72:75], v[168:171], v[108:111], v[72:75]
    s_waitcnt lgkmcnt(3)
    v_mfma_f32_16x16x32_bf16 v[64:67], v[176:179], v[16:19], v[64:67]
    ds_read_b128 v[100:103], v4 offset:43008
    v_mfma_f32_16x16x32_bf16 v[68:71], v[180:183], v[16:19], v[68:71]
    ds_read_b128 v[104:107], v5 offset:40960
    v_mfma_f32_16x16x32_bf16 v[76:79], v[180:183], v[20:23], v[76:79]
    ds_read_b128 v[108:111], v5 offset:43008
    v_mfma_f32_16x16x32_bf16 v[72:75], v[176:179], v[20:23], v[72:75]
    s_waitcnt lgkmcnt(4)
    v_mfma_f32_16x16x32_bf16 v[64:67], v[184:187], v[24:27], v[64:67]
    v_mfma_f32_16x16x32_bf16 v[68:71], v[188:191], v[24:27], v[68:71]
    v_mfma_f32_16x16x32_bf16 v[76:79], v[188:191], v[28:31], v[76:79]
    v_mfma_f32_16x16x32_bf16 v[72:75], v[184:187], v[28:31], v[72:75]
    s_waitcnt vmcnt(6) lgkmcnt(0)
    s_barrier
    s_cmp_lt_u32 s93, 4
    s_cbranch_scc1 L_s_nd8
    s_add_u32 m0, s66, 20480
    s_add_u32 s74, s67, 92544
    buffer_load_dwordx4 v2, s[12:15], s74 offen  lds
    s_add_u32 m0, s66, 24576
    s_add_u32 s74, s67, 110976
    buffer_load_dwordx4 v2, s[12:15], s74 offen  lds
    s_add_u32 m0, s66, 28672
    s_add_u32 s74, s67, 92672
    buffer_load_dwordx4 v2, s[12:15], s74 offen  lds
    s_add_u32 m0, s66, 32768
    s_add_u32 s74, s67, 111104
    buffer_load_dwordx4 v2, s[12:15], s74 offen  lds
    s_add_u32 m0, s66, 36864
    s_add_u32 s74, s67, 92800
    buffer_load_dwordx4 v2, s[12:15], s74 offen  lds
    s_add_u32 m0, s66, 40960
    s_add_u32 s74, s67, 111232
    buffer_load_dwordx4 v2, s[12:15], s74 offen  lds
L_s_nd8:
    v_mfma_f32_16x16x32_bf16 v[64:67], v[192:195], v[96:99], v[64:67]
    ds_read_b128 v[16:19], v6 offset:0
    v_mfma_f32_16x16x32_bf16 v[68:71], v[196:199], v[96:99], v[68:71]
    v_mfma_f32_16x16x32_bf16 v[76:79], v[196:199], v[100:103], v[76:79]
    ds_read_b128 v[20:23], v6 offset:2048
    v_mfma_f32_16x16x32_bf16 v[72:75], v[192:195], v[100:103], v[72:75]
    v_mfma_f32_16x16x32_bf16 v[64:67], v[200:203], v[104:107], v[64:67]
    ds_read_b128 v[24:27], v7 offset:0
    v_mfma_f32_16x16x32_bf16 v[68:71], v[204:207], v[104:107], v[68:71]
    v_mfma_f32_16x16x32_bf16 v[76:79], v[204:207], v[108:111], v[76:79]
    ds_read_b128 v[28:31], v7 offset:2048
    v_mfma_f32_16x16x32_bf16 v[72:75], v[200:203], v[108:111], v[72:75]
    s_waitcnt lgkmcnt(2)
    v_mfma_f32_16x16x32_bf16 v[64:67], v[208:211], v[16:19], v[64:67]
    ds_read_b128 v[96:99], v6 offset:8192
    v_mfma_f32_16x16x32_bf16 v[68:71], v[212:215], v[16:19], v[68:71]
    ds_read_b128 v[100:103], v6 offset:10240
    v_mfma_f32_16x16x32_bf16 v[76:79], v[212:215], v[20:23], v[76:79]
    ds_read_b128 v[104:107], v7 offset:8192
    v_mfma_f32_16x16x32_bf16 v[72:75], v[208:211], v[20:23], v[72:75]
    s_waitcnt lgkmcnt(3)
    v_mfma_f32_16x16x32_bf16 v[64:67], v[216:219], v[24:27], v[64:67]
    ds_read_b128 v[108:111], v7 offset:10240
    v_mfma_f32_16x16x32_bf16 v[68:71], v[220:223], v[24:27], v[68:71]
    v_mfma_f32_16x16x32_bf16 v[76:79], v[220:223], v[28:31], v[76:79]
    ds_read_b128 v[16:19], v6 offset:16384
    v_mfma_f32_16x16x32_bf16 v[72:75], v[216:219], v[28:31], v[72:75]
    s_waitcnt lgkmcnt(3)
    v_mfma_f32_16x16x32_bf16 v[64:67], v[224:227], v[96:99], v[64:67]
    ds_read_b128 v[20:23], v6 offset:18432
    v_mfma_f32_16x16x32_bf16 v[68:71], v[228:231], v[96:99], v[68:71]
    ds_read_b128 v[24:27], v7 offset:16384
    v_mfma_f32_16x16x32_bf16 v[76:79], v[228:231], v[100:103], v[76:79]
    ds_read_b128 v[28:31], v7 offset:18432
    v_mfma_f32_16x16x32_bf16 v[72:75], v[224:227], v[100:103], v[72:75]
    s_waitcnt lgkmcnt(4)
    v_mfma_f32_16x16x32_bf16 v[64:67], v[232:235], v[104:107], v[64:67]
    v_mfma_f32_16x16x32_bf16 v[68:71], v[236:239], v[104:107], v[68:71]
    v_mfma_f32_16x16x32_bf16 v[76:79], v[236:239], v[108:111], v[76:79]
    v_mfma_f32_16x16x32_bf16 v[72:75], v[232:235], v[108:111], v[72:75]
    s_cmp_ge_u32 s93, 4
    s_cbranch_scc1 L_s_w9
    s_waitcnt vmcnt(0)
L_s_w9:
    s_waitcnt vmcnt(6) lgkmcnt(0)
    s_barrier
    s_cmp_lt_u32 s93, 4
    s_cbranch_scc1 L_s_nd9
    s_add_u32 m0, s66, 45056
    s_add_u32 s74, s67, 92928
    buffer_load_dwordx4 v2, s[12:15], s74 offen  lds
    s_add_u32 m0, s66, 49152
    s_add_u32 s74, s67, 111360
    buffer_load_dwordx4 v2, s[12:15], s74 offen  lds
    s_add_u32 m0, s66, 53248
    s_add_u32 s74, s67, 93056
    buffer_load_dwordx4 v2, s[12:15], s74 offen  lds
    s_add_u32 m0, s66, 57344
    s_add_u32 s74, s67, 111488
    buffer_load_dwordx4 v2, s[12:15], s74 offen  lds
    s_add_u32 m0, s66, 61440
    s_add_u32 s74, s67, 93184
    buffer_load_dwordx4 v2, s[12:15], s74 offen  lds
    s_add_u32 m0, s66, 65536
    s_add_u32 s74, s67, 111616
    buffer_load_dwordx4 v2, s[12:15], s74 offen  lds
L_s_nd9:
    v_mfma_f32_16x16x32_bf16 v[64:67], v[240:243], v[16:19], v[64:67]
    ds_read_b128 v[96:99], v4 offset:0
    v_mfma_f32_16x16x32_bf16 v[68:71], v[244:247], v[16:19], v[68:71]
    v_mfma_f32_16x16x32_bf16 v[76:79], v[244:247], v[20:23], v[76:79]
    ds_read_b128 v[100:103], v4 offset:2048
    v_mfma_f32_16x16x32_bf16 v[72:75], v[240:243], v[20:23], v[72:75]
    v_mfma_f32_16x16x32_bf16 v[64:67], v[248:251], v[24:27], v[64:67]
    ds_read_b128 v[104:107], v5 offset:0
    v_mfma_f32_16x16x32_bf16 v[68:71], v[252:255], v[24:27], v[68:71]
    v_mfma_f32_16x16x32_bf16 v[76:79], v[252:255], v[28:31], v[76:79]
    ds_read_b128 v[108:111], v5 offset:2048
    v_mfma_f32_16x16x32_bf16 v[72:75], v[248:251], v[28:31], v[72:75]
    s_waitcnt lgkmcnt(2)
    v_mfma_f32_16x16x32_bf16 v[80:83], v[112:115], v[96:99], 0
    ds_read_b128 v[16:19], v4 offset:8192
    v_mfma_f32_16x16x32_bf16 v[84:87], v[116:119], v[96:99], 0
    ds_read_b128 v[20:23], v4 offset:10240
    v_mfma_f32_16x16x32_bf16 v[92:95], v[116:119], v[100:103], 0
    ds_read_b128 v[24:27], v5 offset:8192
    v_mfma_f32_16x16x32_bf16 v[88:91], v[112:115], v[100:103], 0
    s_waitcnt lgkmcnt(3)
    v_mfma_f32_16x16x32_bf16 v[80:83], v[120:123], v[104:107], v[80:83]
    ds_read_b128 v[28:31], v5 offset:10240
    v_mfma_f32_16x16x32_bf16 v[84:87], v[124:127], v[104:107], v[84:87]
    v_mfma_f32_16x16x32_bf16 v[92:95], v[124:127], v[108:111], v[92:95]
    ds_read_b128 v[96:99], v4 offset:16384
    v_mfma_f32_16x16x32_bf16 v[88:91], v[120:123], v[108:111], v[88:91]
    s_waitcnt lgkmcnt(3)
    v_mfma_f32_16x16x32_bf16 v[80:83], v[128:131], v[16:19], v[80:83]
    ds_read_b128 v[100:103], v4 offset:18432
    v_mfma_f32_16x16x32_bf16 v[84:87], v[132:135], v[16:19], v[84:87]
    ds_read_b128 v[104:107], v5 offset:16384
    v_mfma_f32_16x16x32_bf16 v[92:95], v[132:135], v[20:23], v[92:95]
    ds_read_b128 v[108:111], v5 offset:18432
    v_mfma_f32_16x16x32_bf16 v[88:91], v[128:131], v[20:23], v[88:91]
    s_waitcnt lgkmcnt(4)
    v_mfma_f32_16x16x32_bf16 v[80:83], v[136:139], v[24:27], v[80:83]
    v_mfma_f32_16x16x32_bf16 v[84:87], v[140:143], v[24:27], v[84:87]
    v_mfma_f32_16x16x32_bf16 v[92:95], v[140:143], v[28:31], v[92:95]
    v_mfma_f32_16x16x32_bf16 v[88:91], v[136:139], v[28:31], v[88:91]
    s_waitcnt vmcnt(6) lgkmcnt(0)
    s_barrier
    s_cmp_lt_u32 s93, 4
    s_cbranch_scc1 L_s_nd10
    s_add_u32 m0, s66, -4096
    s_add_u32 s74, s67, 129024
    buffer_load_dwordx4 v2, s[12:15], s74 offen  lds
    s_add_u32 m0, s66, 4096
    s_add_u32 s74, s67, 129152
    buffer_load_dwordx4 v2, s[12:15], s74 offen  lds
    s_add_u32 m0, s66, 12288
    s_add_u32 s74, s67, 129280
    buffer_load_dwordx4 v2, s[12:15], s74 offen  lds
    s_add_u32 m0, s66, 0
    s_add_u32 s74, s67, 129792
    buffer_load_dwordx4 v2, s[12:15], s74 offen  lds
    s_add_u32 m0, s66, 8192
    s_add_u32 s74, s67, 129920
    buffer_load_dwordx4 v2, s[12:15], s74 offen  lds
    s_add_u32 m0, s66, 16384
    s_add_u32 s74, s67, 130048
    buffer_load_dwordx4 v2, s[12:15], s74 offen  lds
L_s_nd10:
    v_mfma_f32_16x16x32_bf16 v[80:83], v[144:147], v[96:99], v[80:83]
    ds_read_b128 v[16:19], v4 offset:24576
    v_mfma_f32_16x16x32_bf16 v[84:87], v[148:151], v[96:99], v[84:87]
    v_mfma_f32_16x16x32_bf16 v[92:95], v[148:151], v[100:103], v[92:95]
    ds_read_b128 v[20:23], v4 offset:26624
    v_mfma_f32_16x16x32_bf16 v[88:91], v[144:147], v[100:103], v[88:91]
    v_mfma_f32_16x16x32_bf16 v[80:83], v[152:155], v[104:107], v[80:83]
    ds_read_b128 v[24:27], v5 offset:24576
    v_mfma_f32_16x16x32_bf16 v[84:87], v[156:159], v[104:107], v[84:87]
    v_mfma_f32_16x16x32_bf16 v[92:95], v[156:159], v[108:111], v[92:95]
    ds_read_b128 v[28:31], v5 offset:26624
    v_mfma_f32_16x16x32_bf16 v[88:91], v[152:155], v[108:111], v[88:91]
    s_waitcnt lgkmcnt(2)
    v_mfma_f32_16x16x32_bf16 v[80:83], v[160:163], v[16:19], v[80:83]
    ds_read_b128 v[96:99], v4 offset:32768
    v_mfma_f32_16x16x32_bf16 v[84:87], v[164:167], v[16:19], v[84:87]
    ds_read_b128 v[100:103], v4 offset:34816
    v_mfma_f32_16x16x32_bf16 v[92:95], v[164:167], v[20:23], v[92:95]
    ds_read_b128 v[104:107], v5 offset:32768
    v_mfma_f32_16x16x32_bf16 v[88:91], v[160:163], v[20:23], v[88:91]
    s_waitcnt lgkmcnt(3)
    v_mfma_f32_16x16x32_bf16 v[80:83], v[168:171], v[24:27], v[80:83]
    ds_read_b128 v[108:111], v5 offset:34816
    v_mfma_f32_16x16x32_bf16 v[84:87], v[172:175], v[24:27], v[84:87]
    v_mfma_f32_16x16x32_bf16 v[92:95], v[172:175], v[28:31], v[92:95]
    ds_read_b128 v[16:19], v4 offset:40960
    v_mfma_f32_16x16x32_bf16 v[88:91], v[168:171], v[28:31], v[88:91]
    s_waitcnt lgkmcnt(3)
    v_mfma_f32_16x16x32_bf16 v[80:83], v[176:179], v[96:99], v[80:83]
    ds_read_b128 v[20:23], v4 offset:43008
    v_mfma_f32_16x16x32_bf16 v[84:87], v[180:183], v[96:99], v[84:87]
    ds_read_b128 v[24:27], v5 offset:40960
    v_mfma_f32_16x16x32_bf16 v[92:95], v[180:183], v[100:103], v[92:95]
    ds_read_b128 v[28:31], v5 offset:43008
    v_mfma_f32_16x16x32_bf16 v[88:91], v[176:179], v[100:103], v[88:91]
    s_waitcnt lgkmcnt(4)
    v_mfma_f32_16x16x32_bf16 v[80:83], v[184:187], v[104:107], v[80:83]
    v_mfma_f32_16x16x32_bf16 v[84:87], v[188:191], v[104:107], v[84:87]
    v_mfma_f32_16x16x32_bf16 v[92:95], v[188:191], v[108:111], v[92:95]
    v_mfma_f32_16x16x32_bf16 v[88:91], v[184:187], v[108:111], v[88:91]
    s_waitcnt vmcnt(6) lgkmcnt(0)
    s_barrier
    s_cmp_lt_u32 s93, 4
    s_cbranch_scc1 L_s_nd11
    s_add_u32 m0, s66, 20480
    s_add_u32 s74, s67, 129408
    buffer_load_dwordx4 v2, s[12:15], s74 offen  lds
    s_add_u32 m0, s66, 28672
    s_add_u32 s74, s67, 129536
    buffer_load_dwordx4 v2, s[12:15], s74 offen  lds
    s_add_u32 m0, s66, 36864
    s_add_u32 s74, s67, 129664
    buffer_load_dwordx4 v2, s[12:15], s74 offen  lds
L_s_nd11:
    v_mfma_f32_16x16x32_bf16 v[80:83], v[192:195], v[16:19], v[80:83]
    ds_read_b128 v[96:99], v6 offset:0
    v_mfma_f32_16x16x32_bf16 v[84:87], v[196:199], v[16:19], v[84:87]
    v_mfma_f32_16x16x32_bf16 v[92:95], v[196:199], v[20:23], v[92:95]
    ds_read_b128 v[100:103], v6 offset:2048
    v_mfma_f32_16x16x32_bf16 v[88:91], v[192:195], v[20:23], v[88:91]
    v_mfma_f32_16x16x32_bf16 v[80:83], v[200:203], v[24:27], v[80:83]
    ds_read_b128 v[104:107], v7 offset:0
    v_mfma_f32_16x16x32_bf16 v[84:87], v[204:207], v[24:27], v[84:87]
    v_mfma_f32_16x16x32_bf16 v[92:95], v[204:207], v[28:31], v[92:95]
    ds_read_b128 v[108:111], v7 offset:2048
    v_mfma_f32_16x16x32_bf16 v[88:91], v[200:203], v[28:31], v[88:91]
    s_waitcnt lgkmcnt(2)
    v_mfma_f32_16x16x32_bf16 v[80:83], v[208:211], v[96:99], v[80:83]
    ds_read_b128 v[16:19], v6 offset:8192
    v_mfma_f32_16x16x32_bf16 v[84:87], v[212:215], v[96:99], v[84:87]
    ds_read_b128 v[20:23], v6 offset:10240
    v_mfma_f32_16x16x32_bf16 v[92:95], v[212:215], v[100:103], v[92:95]
    ds_read_b128 v[24:27], v7 offset:8192
    v_mfma_f32_16x16x32_bf16 v[88:91], v[208:211], v[100:103], v[88:91]
    s_waitcnt lgkmcnt(3)
    v_mfma_f32_16x16x32_bf16 v[80:83], v[216:219], v[104:107], v[80:83]
    ds_read_b128 v[28:31], v7 offset:10240
    v_mfma_f32_16x16x32_bf16 v[84:87], v[220:223], v[104:107], v[84:87]
    v_mfma_f32_16x16x32_bf16 v[92:95], v[220:223], v[108:111], v[92:95]
    ds_read_b128 v[96:99], v6 offset:16384
    v_mfma_f32_16x16x32_bf16 v[88:91], v[216:219], v[108:111], v[88:91]
    s_waitcnt lgkmcnt(3)
    v_mfma_f32_16x16x32_bf16 v[80:83], v[224:227], v[16:19], v[80:83]
    ds_read_b128 v[100:103], v6 offset:18432
    v_mfma_f32_16x16x32_bf16 v[84:87], v[228:231], v[16:19], v[84:87]
    ds_read_b128 v[104:107], v7 offset:16384
    v_mfma_f32_16x16x32_bf16 v[92:95], v[228:231], v[20:23], v[92:95]
    ds_read_b128 v[108:111], v7 offset:18432
    v_mfma_f32_16x16x32_bf16 v[88:91], v[224:227], v[20:23], v[88:91]
    s_waitcnt lgkmcnt(4)
    v_mfma_f32_16x16x32_bf16 v[80:83], v[232:235], v[24:27], v[80:83]
    v_mfma_f32_16x16x32_bf16 v[84:87], v[236:239], v[24:27], v[84:87]
    v_mfma_f32_16x16x32_bf16 v[92:95], v[236:239], v[28:31], v[92:95]
    v_mfma_f32_16x16x32_bf16 v[88:91], v[232:235], v[28:31], v[88:91]
    s_waitcnt vmcnt(0) lgkmcnt(0)
    s_barrier
    s_cmp_eq_u32 s5, 1
    s_cbranch_scc1 L_s_b4alt
    v_mfma_f32_16x16x32_bf16 v[80:83], v[240:243], v[96:99], v[80:83]
    ds_read_b128 v[16:19], v4 offset:0
    v_mfma_f32_16x16x32_bf16 v[84:87], v[244:247], v[96:99], v[84:87]
    v_mfma_f32_16x16x32_bf16 v[92:95], v[244:247], v[100:103], v[92:95]
    ds_read_b128 v[20:23], v4 offset:2048
    v_mfma_f32_16x16x32_bf16 v[88:91], v[240:243], v[100:103], v[88:91]
    v_mfma_f32_16x16x32_bf16 v[80:83], v[248:251], v[104:107], v[80:83]
    ds_read_b128 v[24:27], v5 offset:0
    v_mfma_f32_16x16x32_bf16 v[84:87], v[252:255], v[104:107], v[84:87]
    v_mfma_f32_16x16x32_bf16 v[92:95], v[252:255], v[108:111], v[92:95]
    ds_read_b128 v[28:31], v5 offset:2048
    v_mfma_f32_16x16x32_bf16 v[88:91], v[248:251], v[108:111], v[88:91]
    s_waitcnt lgkmcnt(2)
    v_mfma_f32_16x16x32_bf16 v[96:99], v[112:115], v[16:19], 0
    v_mfma_f32_16x16x32_bf16 v[100:103], v[116:119], v[16:19], 0
    v_mfma_f32_16x16x32_bf16 v[108:111], v[116:119], v[20:23], 0
    v_mfma_f32_16x16x32_bf16 v[104:107], v[112:115], v[20:23], 0
    ds_read_b128 v[112:115], v4 offset:8192
    ds_read_b128 v[116:119], v4 offset:10240
    s_waitcnt lgkmcnt(2)
    v_mfma_f32_16x16x32_bf16 v[96:99], v[120:123], v[24:27], v[96:99]
    v_mfma_f32_16x16x32_bf16 v[100:103], v[124:127], v[24:27], v[100:103]
    v_mfma_f32_16x16x32_bf16 v[108:111], v[124:127], v[28:31], v[108:111]
    v_mfma_f32_16x16x32_bf16 v[104:107], v[120:123], v[28:31], v[104:107]
    ds_read_b128 v[120:123], v5 offset:8192
    ds_read_b128 v[124:127], v5 offset:10240
    s_waitcnt lgkmcnt(2)
    v_mfma_f32_16x16x32_bf16 v[96:99], v[128:131], v[112:115], v[96:99]
    v_mfma_f32_16x16x32_bf16 v[100:103], v[132:135], v[112:115], v[100:103]
    v_mfma_f32_16x16x32_bf16 v[108:111], v[132:135], v[116:119], v[108:111]
    v_mfma_f32_16x16x32_bf16 v[104:107], v[128:131], v[116:119], v[104:107]
    ds_read_b128 v[128:131], v4 offset:16384
    ds_read_b128 v[132:135], v4 offset:18432
    s_waitcnt lgkmcnt(2)
    v_mfma_f32_16x16x32_bf16 v[96:99], v[136:139], v[120:123], v[96:99]
    v_mfma_f32_16x16x32_bf16 v[100:103], v[140:143], v[120:123], v[100:103]
    v_mfma_f32_16x16x32_bf16 v[108:111], v[140:143], v[124:127], v[108:111]
    v_mfma_f32_16x16x32_bf16 v[104:107], v[136:139], v[124:127], v[104:107]
    ds_read_b128 v[136:139], v5 offset:16384
    ds_read_b128 v[140:143], v5 offset:18432
    s_waitcnt lgkmcnt(2)
    v_mfma_f32_16x16x32_bf16 v[96:99], v[144:147], v[128:131], v[96:99]
    v_mfma_f32_16x16x32_bf16 v[100:103], v[148:151], v[128:131], v[100:103]
    v_mfma_f32_16x16x32_bf16 v[108:111], v[148:151], v[132:135], v[108:111]
    v_mfma_f32_16x16x32_bf16 v[104:107], v[144:147], v[132:135], v[104:107]
    ds_read_b128 v[144:147], v4 offset:24576
    ds_read_b128 v[148:151], v4 offset:26624
    s_waitcnt lgkmcnt(2)
    v_mfma_f32_16x16x32_bf16 v[96:99], v[152:155], v[136:139], v[96:99]
    v_mfma_f32_16x16x32_bf16 v[100:103], v[156:159], v[136:139], v[100:103]
    v_mfma_f32_16x16x32_bf16 v[108:111], v[156:159], v[140:143], v[108:111]
    v_mfma_f32_16x16x32_bf16 v[104:107], v[152:155], v[140:143], v[104:107]
    ds_read_b128 v[152:155], v5 offset:24576
    ds_read_b128 v[156:159], v5 offset:26624
    s_waitcnt lgkmcnt(2)
    v_mfma_f32_16x16x32_bf16 v[96:99], v[160:163], v[144:147], v[96:99]
    v_mfma_f32_16x16x32_bf16 v[100:103], v[164:167], v[144:147], v[100:103]
    v_mfma_f32_16x16x32_bf16 v[108:111], v[164:167], v[148:151], v[108:111]
    v_mfma_f32_16x16x32_bf16 v[104:107], v[160:163], v[148:151], v[104:107]
    ds_read_b128 v[160:163], v4 offset:32768
    ds_read_b128 v[164:167], v4 offset:34816
    s_waitcnt lgkmcnt(2)
    v_mfma_f32_16x16x32_bf16 v[96:99], v[168:171], v[152:155], v[96:99]
    v_mfma_f32_16x16x32_bf16 v[100:103], v[172:175], v[152:155], v[100:103]
    v_mfma_f32_16x16x32_bf16 v[108:111], v[172:175], v[156:159], v[108:111]
    v_mfma_f32_16x16x32_bf16 v[104:107], v[168:171], v[156:159], v[104:107]
    ds_read_b128 v[168:171], v5 offset:32768
    ds_read_b128 v[172:175], v5 offset:34816
    s_waitcnt lgkmcnt(2)
    v_mfma_f32_16x16x32_bf16 v[96:99], v[176:179], v[160:163], v[96:99]
    v_mfma_f32_16x16x32_bf16 v[100:103], v[180:183], v[160:163], v[100:103]
    v_mfma_f32_16x16x32_bf16 v[108:111], v[180:183], v[164:167], v[108:111]
    v_mfma_f32_16x16x32_bf16 v[104:107], v[176:179], v[164:167], v[104:107]
    ds_read_b128 v[176:179], v4 offset:40960
    ds_read_b128 v[180:183], v4 offset:43008
    s_waitcnt lgkmcnt(2)
    v_mfma_f32_16x16x32_bf16 v[96:99], v[184:187], v[168:171], v[96:99]
    v_mfma_f32_16x16x32_bf16 v[100:103], v[188:191], v[168:171], v[100:103]
    v_mfma_f32_16x16x32_bf16 v[108:111], v[188:191], v[172:175], v[108:111]
    v_mfma_f32_16x16x32_bf16 v[104:107], v[184:187], v[172:175], v[104:107]
    ds_read_b128 v[184:187], v5 offset:40960
    ds_read_b128 v[188:191], v5 offset:43008
    s_waitcnt lgkmcnt(2)
    v_mfma_f32_16x16x32_bf16 v[96:99], v[192:195], v[176:179], v[96:99]
    v_mfma_f32_16x16x32_bf16 v[100:103], v[196:199], v[176:179], v[100:103]
    v_mfma_f32_16x16x32_bf16 v[108:111], v[196:199], v[180:183], v[108:111]
    v_mfma_f32_16x16x32_bf16 v[104:107], v[192:195], v[180:183], v[104:107]
    ds_read_b128 v[192:195], v4 offset:4096
    ds_read_b128 v[196:199], v4 offset:6144
    s_waitcnt lgkmcnt(2)
    v_mfma_f32_16x16x32_bf16 v[96:99], v[200:203], v[184:187], v[96:99]
    v_mfma_f32_16x16x32_bf16 v[100:103], v[204:207], v[184:187], v[100:103]
    v_mfma_f32_16x16x32_bf16 v[108:111], v[204:207], v[188:191], v[108:111]
    v_mfma_f32_16x16x32_bf16 v[104:107], v[200:203], v[188:191], v[104:107]
    ds_read_b128 v[200:203], v5 offset:4096
    ds_read_b128 v[204:207], v5 offset:6144
    s_waitcnt lgkmcnt(2)
    v_mfma_f32_16x16x32_bf16 v[96:99], v[208:211], v[192:195], v[96:99]
    v_mfma_f32_16x16x32_bf16 v[100:103], v[212:215], v[192:195], v[100:103]
    v_mfma_f32_16x16x32_bf16 v[108:111], v[212:215], v[196:199], v[108:111]
    v_mfma_f32_16x16x32_bf16 v[104:107], v[208:211], v[196:199], v[104:107]
    ds_read_b128 v[208:211], v4 offset:12288
    ds_read_b128 v[212:215], v4 offset:14336
    v_lshrrev_b32 v9, 4, v1
    v_and_b32 v10, 15, v1
    s_lshl_b32 s76, s5, 9
    s_add_u32 s76, s76, 158208
    v_lshlrev_b32 v11, 5, v10
    v_add_u32 v11, s76, v11
    v_mul_u32_u24 v12, 144, v9
    v_add_u32 v12, v12, v10
    s_mul_i32 s76, s4, 576
    s_lshl_b32 s77, s5, 4
    s_add_u32 s76, s76, s77
    v_add_lshl_u32 v12, v12, s76, 3
    v_add_u32 v12, 55296, v12
    s_waitcnt lgkmcnt(2)
    v_mfma_f32_16x16x32_bf16 v[96:99], v[216:219], v[200:203], v[96:99]
    v_mfma_f32_16x16x32_bf16 v[100:103], v[220:223], v[200:203], v[100:103]
    v_mfma_f32_16x16x32_bf16 v[108:111], v[220:223], v[204:207], v[108:111]
    v_mfma_f32_16x16x32_bf16 v[104:107], v[216:219], v[204:207], v[104:107]
    ds_read_b128 v[216:219], v5 offset:12288
    ds_read_b128 v[220:223], v5 offset:14336
    s_waitcnt lgkmcnt(2)
    v_mfma_f32_16x16x32_bf16 v[96:99], v[224:227], v[208:211], v[96:99]
    v_mfma_f32_16x16x32_bf16 v[100:103], v[228:231], v[208:211], v[100:103]
    v_mfma_f32_16x16x32_bf16 v[108:111], v[228:231], v[212:215], v[108:111]
    v_mfma_f32_16x16x32_bf16 v[104:107], v[224:227], v[212:215], v[104:107]
    ds_read_b128 v[224:227], v4 offset:20480
    ds_read_b128 v[228:231], v4 offset:22528
    s_waitcnt lgkmcnt(2)
    v_mfma_f32_16x16x32_bf16 v[96:99], v[232:235], v[216:219], v[96:99]
    v_mfma_f32_16x16x32_bf16 v[100:103], v[236:239], v[216:219], v[100:103]
    v_mfma_f32_16x16x32_bf16 v[108:111], v[236:239], v[220:223], v[108:111]
    v_mfma_f32_16x16x32_bf16 v[104:107], v[232:235], v[220:223], v[104:107]
    ds_read_b128 v[232:235], v5 offset:20480
    ds_read_b128 v[236:239], v5 offset:22528
    s_waitcnt lgkmcnt(2)
    v_mfma_f32_16x16x32_bf16 v[96:99], v[240:243], v[224:227], v[96:99]
    v_mfma_f32_16x16x32_bf16 v[100:103], v[244:247], v[224:227], v[100:103]
    v_mfma_f32_16x16x32_bf16 v[108:111], v[244:247], v[228:231], v[108:111]
    v_mfma_f32_16x16x32_bf16 v[104:107], v[240:243], v[228:231], v[104:107]
    ds_read_b128 v[112:115], v11 offset:0
    ds_read_b128 v[116:119], v11 offset:1024
    ds_read_b128 v[120:123], v11 offset:2048
    ds_read_b128 v[124:127], v11 offset:3072
    ds_read_b128 v[128:131], v11 offset:4096
    s_lshl_b32 s76, s4, 8
    s_add_u32 s76, s76, 157184
    v_lshlrev_b32 v3, 6, v9
    v_add_u32 v3, s76, v3
    ds_read_b128 v[160:163], v3 offset:0
    ds_read_b128 v[164:167], v3 offset:16
    ds_read_b128 v[168:171], v3 offset:32
    ds_read_b128 v[172:175], v3 offset:48
    s_waitcnt lgkmcnt(9)
    v_mfma_f32_16x16x32_bf16 v[96:99], v[248:251], v[232:235], v[96:99]
    v_mfma_f32_16x16x32_bf16 v[100:103], v[252:255], v[232:235], v[100:103]
    v_mfma_f32_16x16x32_bf16 v[108:111], v[252:255], v[236:239], v[108:111]
    v_mfma_f32_16x16x32_bf16 v[104:107], v[248:251], v[236:239], v[104:107]
    s_waitcnt lgkmcnt(0)
    s_nop 6
    v_mul_f32 v32, v161, v32
    v_mul_f32 v40, v161, v40
    v_mul_f32 v33, v163, v33
    v_mul_f32 v41, v163, v41
    v_mul_f32 v34, v165, v34
    v_mul_f32 v42, v165, v42
    v_mul_f32 v35, v167, v35
    v_mul_f32 v43, v167, v43
    v_mul_f32 v36, v169, v36
    v_mul_f32 v44, v169, v44
    v_mul_f32 v37, v171, v37
    v_mul_f32 v45, v171, v45
    v_mul_f32 v38, v173, v38
    v_mul_f32 v46, v173, v46
    v_mul_f32 v39, v175, v39
    v_mul_f32 v47, v175, v47
    v_mul_f32 v48, v161, v48
    v_mul_f32 v56, v161, v56
    v_mul_f32 v49, v163, v49
    v_mul_f32 v57, v163, v57
    v_mul_f32 v50, v165, v50
    v_mul_f32 v58, v165, v58
    v_mul_f32 v51, v167, v51
    v_mul_f32 v59, v167, v59
    v_mul_f32 v52, v169, v52
    v_mul_f32 v60, v169, v60
    v_mul_f32 v53, v171, v53
    v_mul_f32 v61, v171, v61
    v_mul_f32 v54, v173, v54
    v_mul_f32 v62, v173, v62
    v_mul_f32 v55, v175, v55
    v_mul_f32 v63, v175, v63
    v_mul_f32 v64, v161, v64
    v_mul_f32 v72, v161, v72
    v_mul_f32 v65, v163, v65
    v_mul_f32 v73, v163, v73
    v_mul_f32 v66, v165, v66
    v_mul_f32 v74, v165, v74
    v_mul_f32 v67, v167, v67
    v_mul_f32 v75, v167, v75
    v_mul_f32 v68, v169, v68
    v_mul_f32 v76, v169, v76
    v_mul_f32 v69, v171, v69
    v_mul_f32 v77, v171, v77
    v_mul_f32 v70, v173, v70
    v_mul_f32 v78, v173, v78
    v_mul_f32 v71, v175, v71
    v_mul_f32 v79, v175, v79
    v_mul_f32 v80, v161, v80
    v_mul_f32 v88, v161, v88
    v_mul_f32 v81, v163, v81
    v_mul_f32 v89, v163, v89
    v_mul_f32 v82, v165, v82
    v_mul_f32 v90, v165, v90
    v_mul_f32 v83, v167, v83
    v_mul_f32 v91, v167, v91
    v_mul_f32 v84, v169, v84
    v_mul_f32 v92, v169, v92
    v_mul_f32 v85, v171, v85
    v_mul_f32 v93, v171, v93
    v_mul_f32 v86, v173, v86
    v_mul_f32 v94, v173, v94
    v_mul_f32 v87, v175, v87
    v_mul_f32 v95, v175, v95
    v_mul_f32 v96, v161, v96
    v_mul_f32 v104, v161, v104
    v_mul_f32 v97, v163, v97
    v_mul_f32 v105, v163, v105
    v_mul_f32 v98, v165, v98
    v_mul_f32 v106, v165, v106
    v_mul_f32 v99, v167, v99
    v_mul_f32 v107, v167, v107
    v_mul_f32 v100, v169, v100
    v_mul_f32 v108, v169, v108
    v_mul_f32 v101, v171, v101
    v_mul_f32 v109, v171, v109
    v_mul_f32 v102, v173, v102
    v_mul_f32 v110, v173, v110
    v_mul_f32 v103, v175, v103
    v_mul_f32 v111, v175, v111
    v_fma_f32 v134, v112, v32, v33
    v_fma_f32 v138, v116, v48, v49
    v_fma_f32 v142, v120, v64, v65
    v_fma_f32 v146, v124, v80, v81
    v_fma_f32 v150, v128, v96, v97
    v_fma_f32 v135, v112, v40, v41
    v_fma_f32 v139, v116, v56, v57
    v_fma_f32 v143, v120, v72, v73
    v_fma_f32 v147, v124, v88, v89
    v_fma_f32 v151, v128, v104, v105
    v_fma_f32 v134, -v113, v40, v134
    v_fma_f32 v138, -v117, v56, v138
    v_fma_f32 v142, -v121, v72, v142
    v_fma_f32 v146, -v125, v88, v146
    v_fma_f32 v150, -v129, v104, v150
    v_fmac_f32 v135, v113, v32
    v_fmac_f32 v139, v117, v48
    v_fmac_f32 v143, v121, v64
    v_fmac_f32 v147, v125, v80
    v_fmac_f32 v151, v129, v96
    v_fma_f32 v132, v112, v134, v34
    v_fma_f32 v136, v116, v138, v50
    v_fma_f32 v140, v120, v142, v66
    v_fma_f32 v144, v124, v146, v82
    v_fma_f32 v148, v128, v150, v98
    v_fma_f32 v133, v112, v135, v42
    v_fma_f32 v137, v116, v139, v58
    v_fma_f32 v141, v120, v143, v74
    v_fma_f32 v145, v124, v147, v90
    v_fma_f32 v149, v128, v151, v106
    v_fma_f32 v132, -v113, v135, v132
    v_fma_f32 v136, -v117, v139, v136
    v_fma_f32 v140, -v121, v143, v140
    v_fma_f32 v144, -v125, v147, v144
    v_fma_f32 v148, -v129, v151, v148
    v_fmac_f32 v133, v113, v134
    v_fmac_f32 v137, v117, v138
    v_fmac_f32 v141, v121, v142
    v_fmac_f32 v145, v125, v146
    v_fmac_f32 v149, v129, v150
    v_fma_f32 v134, v112, v132, v35
    v_fma_f32 v138, v116, v136, v51
    v_fma_f32 v142, v120, v140, v67
    v_fma_f32 v146, v124, v144, v83
    v_fma_f32 v150, v128, v148, v99
    v_fma_f32 v135, v112, v133, v43
    v_fma_f32 v139, v116, v137, v59
    v_fma_f32 v143, v120, v141, v75
    v_fma_f32 v147, v124, v145, v91
    v_fma_f32 v151, v128, v149, v107
    v_fma_f32 v134, -v113, v133, v134
    v_fma_f32 v138, -v117, v137, v138
    v_fma_f32 v142, -v121, v141, v142
    v_fma_f32 v146, -v125, v145, v146
    v_fma_f32 v150, -v129, v149, v150
    v_fmac_f32 v135, v113, v132
    v_fmac_f32 v139, v117, v136
    v_fmac_f32 v143, v121, v140
    v_fmac_f32 v147, v125, v144
    v_fmac_f32 v151, v129, v148
    v_fma_f32 v132, v112, v134, v36
    v_fma_f32 v136, v116, v138, v52
    v_fma_f32 v140, v120, v142, v68
    v_fma_f32 v144, v124, v146, v84
    v_fma_f32 v148, v128, v150, v100
    v_fma_f32 v133, v112, v135, v44
    v_fma_f32 v137, v116, v139, v60
    v_fma_f32 v141, v120, v143, v76
    v_fma_f32 v145, v124, v147, v92
    v_fma_f32 v149, v128, v151, v108
    v_fma_f32 v132, -v113, v135, v132
    v_fma_f32 v136, -v117, v139, v136
    v_fma_f32 v140, -v121, v143, v140
    v_fma_f32 v144, -v125, v147, v144
    v_fma_f32 v148, -v129, v151, v148
    v_fmac_f32 v133, v113, v134
    v_fmac_f32 v137, v117, v138
    v_fmac_f32 v141, v121, v142
    v_fmac_f32 v145, v125, v146
    v_fmac_f32 v149, v129, v150
    v_fma_f32 v134, v112, v132, v37
    v_fma_f32 v138, v116, v136, v53
    v_fma_f32 v142, v120, v140, v69
    v_fma_f32 v146, v124, v144, v85
    v_fma_f32 v150, v128, v148, v101
    v_fma_f32 v135, v112, v133, v45
    v_fma_f32 v139, v116, v137, v61
    v_fma_f32 v143, v120, v141, v77
    v_fma_f32 v147, v124, v145, v93
    v_fma_f32 v151, v128, v149, v109
    v_fma_f32 v134, -v113, v133, v134
    v_fma_f32 v138, -v117, v137, v138
    v_fma_f32 v142, -v121, v141, v142
    v_fma_f32 v146, -v125, v145, v146
    v_fma_f32 v150, -v129, v149, v150
    v_fmac_f32 v135, v113, v132
    v_fmac_f32 v139, v117, v136
    v_fmac_f32 v143, v121, v140
    v_fmac_f32 v147, v125, v144
    v_fmac_f32 v151, v129, v148
    v_fma_f32 v132, v112, v134, v38
    v_fma_f32 v136, v116, v138, v54
    v_fma_f32 v140, v120, v142, v70
    v_fma_f32 v144, v124, v146, v86
    v_fma_f32 v148, v128, v150, v102
    v_fma_f32 v133, v112, v135, v46
    v_fma_f32 v137, v116, v139, v62
    v_fma_f32 v141, v120, v143, v78
    v_fma_f32 v145, v124, v147, v94
    v_fma_f32 v149, v128, v151, v110
    v_fma_f32 v132, -v113, v135, v132
    v_fma_f32 v136, -v117, v139, v136
    v_fma_f32 v140, -v121, v143, v140
    v_fma_f32 v144, -v125, v147, v144
    v_fma_f32 v148, -v129, v151, v148
    v_fmac_f32 v133, v113, v134
    v_fmac_f32 v137, v117, v138
    v_fmac_f32 v141, v121, v142
    v_fmac_f32 v145, v125, v146
    v_fmac_f32 v149, v129, v150
    v_fma_f32 v134, v112, v132, v39
    v_fma_f32 v138, v116, v136, v55
    v_fma_f32 v142, v120, v140, v71
    v_fma_f32 v146, v124, v144, v87
    v_fma_f32 v150, v128, v148, v103
    v_fma_f32 v135, v112, v133, v47
    v_fma_f32 v139, v116, v137, v63
    v_fma_f32 v143, v120, v141, v79
    v_fma_f32 v147, v124, v145, v95
    v_fma_f32 v151, v128, v149, v111
    v_fma_f32 v134, -v113, v133, v134
    v_fma_f32 v138, -v117, v137, v138
    v_fma_f32 v142, -v121, v141, v142
    v_fma_f32 v146, -v125, v145, v146
    v_fma_f32 v150, -v129, v149, v150
    v_fmac_f32 v135, v113, v132
    v_fmac_f32 v139, v117, v136
    v_fmac_f32 v143, v121, v140
    v_fmac_f32 v147, v125, v144
    v_fmac_f32 v151, v129, v148
    ds_write_b64 v12, v[134:135] offset:0
    ds_write_b64 v12, v[138:139] offset:256
    ds_write_b64 v12, v[142:143] offset:512
    ds_write_b64 v12, v[146:147] offset:768
    ds_write_b64 v12, v[150:151] offset:1024
    s_waitcnt lgkmcnt(0)
    s_barrier
    s_and_b32 s76, s3, 1
    s_mul_i32 s77, s76, 320
    s_bfe_u32 s75, s3, 0x10001
    s_mul_i32 s66, s75, 10240
    s_mul_i32 s75, s75, 36864
    v_add_u32 v3, s77, v1
    v_mul_u32_u24 v8, 3277, v3
    v_lshrrev_b32 v8, 16, v8
    v_lshrrev_b32 v20, 2, v8
    v_sub_u32 v20, 0, v20
    v_and_b32 v20, 3, v20
    v_xor_b32 v3, v3, v20
    v_mul_u32_u24 v8, 832, v8
    v_lshl_add_u32 v8, v3, 4, v8
    v_add_u32 v232, s75, v8
    v_add_u32 v3, s77, v1
    v_add_u32 v3, 64, v3
    v_mul_u32_u24 v8, 3277, v3
    v_lshrrev_b32 v8, 16, v8
    v_lshrrev_b32 v20, 2, v8
    v_sub_u32 v20, 0, v20
    v_and_b32 v20, 3, v20
    v_xor_b32 v3, v3, v20
    v_mul_u32_u24 v8, 832, v8
    v_lshl_add_u32 v8, v3, 4, v8
    v_add_u32 v233, s75, v8
    v_add_u32 v3, s77, v1
    v_add_u32 v3, 128, v3
    v_mul_u32_u24 v8, 3277, v3
    v_lshrrev_b32 v8, 16, v8
    v_lshrrev_b32 v20, 2, v8
    v_sub_u32 v20, 0, v20
    v_and_b32 v20, 3, v20
    v_xor_b32 v3, v3, v20
    v_mul_u32_u24 v8, 832, v8
    v_lshl_add_u32 v8, v3, 4, v8
    v_add_u32 v234, s75, v8
    v_add_u32 v3, s77, v1
    v_add_u32 v3, 192, v3
    v_mul_u32_u24 v8, 3277, v3
    v_lshrrev_b32 v8, 16, v8
    v_lshrrev_b32 v20, 2, v8
    v_sub_u32 v20, 0, v20
    v_and_b32 v20, 3, v20
    v_xor_b32 v3, v3, v20
    v_mul_u32_u24 v8, 832, v8
    v_lshl_add_u32 v8, v3, 4, v8
    v_add_u32 v235, s75, v8
    v_add_u32 v3, s77, v1
    v_add_u32 v3, 256, v3
    v_mul_u32_u24 v8, 3277, v3
    v_lshrrev_b32 v8, 16, v8
    v_lshrrev_b32 v20, 2, v8
    v_sub_u32 v20, 0, v20
    v_and_b32 v20, 3, v20
    v_xor_b32 v3, v3, v20
    v_mul_u32_u24 v8, 832, v8
    v_lshl_add_u32 v8, v3, 4, v8
    v_add_u32 v236, s75, v8
    s_mul_i32 s76, s76, 5120
    s_add_u32 s66, s66, s76
    s_and_b32 s85, s85, 0xffffffc0
    s_mov_b32 s12, s42
    s_mov_b32 s13, s43
    s_mov_b32 s14, 663552
    s_mov_b32 s15, 0x20000
    s_mov_b32 s16, s44
    s_mov_b32 s17, s45
    s_mov_b32 s18, 663552
    s_mov_b32 s19, 0x20000
    s_add_u32 m0, s66, 20480
    s_nop 0
    buffer_load_dwordx4 v232, s[16:19], s85 offen  lds
    s_add_u32 m0, s66, 21504
    s_nop 0
    buffer_load_dwordx4 v233, s[16:19], s85 offen  lds
    s_add_u32 m0, s66, 22528
    s_nop 0
    buffer_load_dwordx4 v234, s[16:19], s85 offen  lds
    s_add_u32 m0, s66, 23552
    s_nop 0
    buffer_load_dwordx4 v235, s[16:19], s85 offen  lds
    s_add_u32 m0, s66, 24576
    s_nop 0
    buffer_load_dwordx4 v236, s[16:19], s85 offen  lds
    s_add_u32 m0, s66, 0
    s_nop 0
    buffer_load_dwordx4 v232, s[12:15], s85 offen  lds
    s_add_u32 m0, s66, 1024
    s_nop 0
    buffer_load_dwordx4 v233, s[12:15], s85 offen  lds
    s_add_u32 m0, s66, 2048
    s_nop 0
    buffer_load_dwordx4 v234, s[12:15], s85 offen  lds
    s_add_u32 m0, s66, 3072
    s_nop 0
    buffer_load_dwordx4 v235, s[12:15], s85 offen  lds
    s_add_u32 m0, s66, 4096
    s_nop 0
    buffer_load_dwordx4 v236, s[12:15], s85 offen  lds
    v_mul_f32 v224, v115, v40
    v_mul_f32 v225, v115, v41
    v_mul_f32 v226, v115, v42
    v_mul_f32 v227, v115, v43
    v_mul_f32 v228, v115, v44
    v_mul_f32 v229, v115, v45
    v_mul_f32 v230, v115, v46
    v_mul_f32 v231, v115, v47
    v_mul_f32 v40, v114, v40
    v_mul_f32 v41, v114, v41
    v_mul_f32 v42, v114, v42
    v_mul_f32 v43, v114, v43
    v_mul_f32 v44, v114, v44
    v_mul_f32 v45, v114, v45
    v_mul_f32 v46, v114, v46
    v_mul_f32 v47, v114, v47
    v_fmac_f32 v40, v115, v32
    v_fmac_f32 v41, v115, v33
    v_fmac_f32 v42, v115, v34
    v_fmac_f32 v43, v115, v35
    v_fmac_f32 v44, v115, v36
    v_fmac_f32 v45, v115, v37
    v_fmac_f32 v46, v115, v38
    v_fmac_f32 v47, v115, v39
    v_fma_f32 v32, v114, v32, -v224
    v_fma_f32 v33, v114, v33, -v225
    v_fma_f32 v34, v114, v34, -v226
    v_fma_f32 v35, v114, v35, -v227
    v_fma_f32 v36, v114, v36, -v228
    v_fma_f32 v37, v114, v37, -v229
    v_fma_f32 v38, v114, v38, -v230
    v_fma_f32 v39, v114, v39, -v231
    v_mul_f32 v224, v119, v56
    v_mul_f32 v225, v119, v57
    v_mul_f32 v226, v119, v58
    v_mul_f32 v227, v119, v59
    v_mul_f32 v228, v119, v60
    v_mul_f32 v229, v119, v61
    v_mul_f32 v230, v119, v62
    v_mul_f32 v231, v119, v63
    v_mul_f32 v56, v118, v56
    v_mul_f32 v57, v118, v57
    v_mul_f32 v58, v118, v58
    v_mul_f32 v59, v118, v59
    v_mul_f32 v60, v118, v60
    v_mul_f32 v61, v118, v61
    v_mul_f32 v62, v118, v62
    v_mul_f32 v63, v118, v63
    v_fmac_f32 v56, v119, v48
    v_fmac_f32 v57, v119, v49
    v_fmac_f32 v58, v119, v50
    v_fmac_f32 v59, v119, v51
    v_fmac_f32 v60, v119, v52
    v_fmac_f32 v61, v119, v53
    v_fmac_f32 v62, v119, v54
    v_fmac_f32 v63, v119, v55
    v_fma_f32 v48, v118, v48, -v224
    v_fma_f32 v49, v118, v49, -v225
    v_fma_f32 v50, v118, v50, -v226
    v_fma_f32 v51, v118, v51, -v227
    v_fma_f32 v52, v118, v52, -v228
    v_fma_f32 v53, v118, v53, -v229
    v_fma_f32 v54, v118, v54, -v230
    v_fma_f32 v55, v118, v55, -v231
    v_mul_f32 v224, v123, v72
    v_mul_f32 v225, v123, v73
    v_mul_f32 v226, v123, v74
    v_mul_f32 v227, v123, v75
    v_mul_f32 v228, v123, v76
    v_mul_f32 v229, v123, v77
    v_mul_f32 v230, v123, v78
    v_mul_f32 v231, v123, v79
    v_mul_f32 v72, v122, v72
    v_mul_f32 v73, v122, v73
    v_mul_f32 v74, v122, v74
    v_mul_f32 v75, v122, v75
    v_mul_f32 v76, v122, v76
    v_mul_f32 v77, v122, v77
    v_mul_f32 v78, v122, v78
    v_mul_f32 v79, v122, v79
    v_fmac_f32 v72, v123, v64
    v_fmac_f32 v73, v123, v65
    v_fmac_f32 v74, v123, v66
    v_fmac_f32 v75, v123, v67
    v_fmac_f32 v76, v123, v68
    v_fmac_f32 v77, v123, v69
    v_fmac_f32 v78, v123, v70
    v_fmac_f32 v79, v123, v71
    v_fma_f32 v64, v122, v64, -v224
    v_fma_f32 v65, v122, v65, -v225
    v_fma_f32 v66, v122, v66, -v226
    v_fma_f32 v67, v122, v67, -v227
    v_fma_f32 v68, v122, v68, -v228
    v_fma_f32 v69, v122, v69, -v229
    v_fma_f32 v70, v122, v70, -v230
    v_fma_f32 v71, v122, v71, -v231
    v_mul_f32 v224, v127, v88
    v_mul_f32 v225, v127, v89
    v_mul_f32 v226, v127, v90
    v_mul_f32 v227, v127, v91
    v_mul_f32 v228, v127, v92
    v_mul_f32 v229, v127, v93
    v_mul_f32 v230, v127, v94
    v_mul_f32 v231, v127, v95
    v_mul_f32 v88, v126, v88
    v_mul_f32 v89, v126, v89
    v_mul_f32 v90, v126, v90
    v_mul_f32 v91, v126, v91
    v_mul_f32 v92, v126, v92
    v_mul_f32 v93, v126, v93
    v_mul_f32 v94, v126, v94
    v_mul_f32 v95, v126, v95
    v_fmac_f32 v88, v127, v80
    v_fmac_f32 v89, v127, v81
    v_fmac_f32 v90, v127, v82
    v_fmac_f32 v91, v127, v83
    v_fmac_f32 v92, v127, v84
    v_fmac_f32 v93, v127, v85
    v_fmac_f32 v94, v127, v86
    v_fmac_f32 v95, v127, v87
    v_fma_f32 v80, v126, v80, -v224
    v_fma_f32 v81, v126, v81, -v225
    v_fma_f32 v82, v126, v82, -v226
    v_fma_f32 v83, v126, v83, -v227
    v_fma_f32 v84, v126, v84, -v228
    v_fma_f32 v85, v126, v85, -v229
    v_fma_f32 v86, v126, v86, -v230
    v_fma_f32 v87, v126, v87, -v231
    v_mul_f32 v224, v131, v104
    v_mul_f32 v225, v131, v105
    v_mul_f32 v226, v131, v106
    v_mul_f32 v227, v131, v107
    v_mul_f32 v228, v131, v108
    v_mul_f32 v229, v131, v109
    v_mul_f32 v230, v131, v110
    v_mul_f32 v231, v131, v111
    v_mul_f32 v104, v130, v104
    v_mul_f32 v105, v130, v105
    v_mul_f32 v106, v130, v106
    v_mul_f32 v107, v130, v107
    v_mul_f32 v108, v130, v108
    v_mul_f32 v109, v130, v109
    v_mul_f32 v110, v130, v110
    v_mul_f32 v111, v130, v111
    v_fmac_f32 v104, v131, v96
    v_fmac_f32 v105, v131, v97
    v_fmac_f32 v106, v131, v98
    v_fmac_f32 v107, v131, v99
    v_fmac_f32 v108, v131, v100
    v_fmac_f32 v109, v131, v101
    v_fmac_f32 v110, v131, v102
    v_fmac_f32 v111, v131, v103
    v_fma_f32 v96, v130, v96, -v224
    v_fma_f32 v97, v130, v97, -v225
    v_fma_f32 v98, v130, v98, -v226
    v_fma_f32 v99, v130, v99, -v227
    v_fma_f32 v100, v130, v100, -v228
    v_fma_f32 v101, v130, v101, -v229
    v_fma_f32 v102, v130, v102, -v230
    v_fma_f32 v103, v130, v103, -v231
    v_and_b32 v3, 3, v10
    v_lshlrev_b32 v3, 1, v3
    v_bfe_u32 v8, v10, 2, 1
    v_add_u32 v3, v3, v8
    v_and_b32 v8, 8, v10
    v_add_u32 v3, v3, v8
    s_lshl_b32 s76, s4, 2
    v_add_u32 v8, s76, v9
    v_xor_b32 v3, v3, v8
    v_lshlrev_b32 v3, 4, v3
    v_lshl_add_u32 v27, v10, 8, v3
    s_lshl_b32 s76, s5, 13
    s_add_u32 s76, s76, 81920
    v_add_u32 v27, s76, v27
    v_add_u32 v28, 65536, v27
    v_bfe_u32 v3, v1, 2, 2
    v_lshl_add_u32 v8, v9, 3, v3
    v_lshlrev_b32 v240, 8, v8
    v_lshlrev_b32 v3, 1, v3
    v_and_b32 v8, 8, v8
    v_add_u32 v3, v3, v8
    v_bfe_u32 v8, v1, 1, 1
    s_lshl_b32 s76, s4, 2
    v_add_u32 v8, s76, v8
    v_xor_b32 v3, v3, v8
    v_lshl_add_u32 v240, v3, 4, v240
    v_and_b32 v3, 1, v1
    v_lshl_add_u32 v240, v3, 3, v240
    v_add_u32 v240, 81920, v240
    v_xor_b32 v241, 16, v240
    v_xor_b32 v242, 32, v240
    v_xor_b32 v243, 48, v240
    v_lshrrev_b32 v3, 1, v9
    v_lshl_add_u32 v3, v3, 6, v10
    s_lshl_b32 s76, s5, 5
    v_add_u32 v3, s76, v3
    v_mul_u32_u24 v5, 320, v3
    v_lshrrev_b32 v8, 2, v10
    v_sub_u32 v8, 0, v8
    v_and_b32 v8, 3, v8
    s_and_b32 s76, s81, 1
    s_lshl_b32 s76, s76, 1
    v_and_b32 v3, 1, v9
    v_add_u32 v3, s76, v3
    v_xor_b32 v4, v3, v8
    v_lshl_add_u32 v4, v4, 4, v5
    v_add_u32 v3, 2, v3
    v_xor_b32 v3, v3, v8
    v_lshl_add_u32 v5, v3, 4, v5
    s_branch L_s_xdone
L_s_b4alt:
    s_setprio 1
    v_mfma_f32_16x16x32_bf16 v[80:83], v[240:243], v[96:99], v[80:83]
    v_mfma_f32_16x16x32_bf16 v[84:87], v[244:247], v[96:99], v[84:87]
    v_mfma_f32_16x16x32_bf16 v[92:95], v[244:247], v[100:103], v[92:95]
    v_mfma_f32_16x16x32_bf16 v[88:91], v[240:243], v[100:103], v[88:91]
    v_mfma_f32_16x16x32_bf16 v[80:83], v[248:251], v[104:107], v[80:83]
    v_mfma_f32_16x16x32_bf16 v[84:87], v[252:255], v[104:107], v[84:87]
    v_mfma_f32_16x16x32_bf16 v[92:95], v[252:255], v[108:111], v[92:95]
    v_mfma_f32_16x16x32_bf16 v[88:91], v[248:251], v[108:111], v[88:91]
    s_setprio 0
    v_lshrrev_b32 v9, 4, v1
    v_and_b32 v10, 15, v1
    s_lshl_b32 s76, s5, 9
    s_add_u32 s76, s76, 158208
    v_lshlrev_b32 v11, 5, v10
    v_add_u32 v11, s76, v11
    v_mul_u32_u24 v12, 144, v9
    v_add_u32 v12, v12, v10
    s_mul_i32 s76, s4, 576
    s_lshl_b32 s77, s5, 4
    s_add_u32 s76, s76, s77
    v_add_lshl_u32 v12, v12, s76, 3
    v_add_u32 v12, 55296, v12
    ds_read_b128 v[112:115], v11 offset:0
    ds_read_b128 v[116:119], v11 offset:1024
    ds_read_b128 v[120:123], v11 offset:2048
    ds_read_b128 v[124:127], v11 offset:3072
    s_lshl_b32 s76, s4, 8
    s_add_u32 s76, s76, 157184
    v_lshlrev_b32 v3, 6, v9
    v_add_u32 v3, s76, v3
    ds_read_b128 v[160:163], v3 offset:0
    ds_read_b128 v[164:167], v3 offset:16
    ds_read_b128 v[168:171], v3 offset:32
    ds_read_b128 v[172:175], v3 offset:48
    s_lshl_b32 s76, s6, 4
    s_add_u32 s76, s76, 0
    v_mov_b32 v18, s7
    v_writelane_b32 v18, s76, 0
    buffer_load_ubyte v19, v18, s[28:31], 0 offen sc1
    v_and_b32 v3, 255, v0
    v_min_u32 v3, 215, v3
    v_mul_u32_u24 v8, 171, v3
    v_lshrrev_b32 v8, 9, v8
    v_mul_u32_u24 v8, 768, v8
    v_lshl_add_u32 v8, v3, 7, v8
    s_lshl_b32 s76, s81, 8
    s_mul_i32 s75, s87, 82944
    s_add_u32 s75, s75, s76
    v_add_u32 v20, s75, v8
    global_load_dword v21, v20, s[42:43]
    s_waitcnt lgkmcnt(0)
    v_mul_f32 v32, v161, v32
    v_mul_f32 v40, v161, v40
    v_mul_f32 v33, v163, v33
    v_mul_f32 v41, v163, v41
    v_mul_f32 v34, v165, v34
    v_mul_f32 v42, v165, v42
    v_mul_f32 v35, v167, v35
    v_mul_f32 v43, v167, v43
    v_mul_f32 v36, v169, v36
    v_mul_f32 v44, v169, v44
    v_mul_f32 v37, v171, v37
    v_mul_f32 v45, v171, v45
    v_mul_f32 v38, v173, v38
    v_mul_f32 v46, v173, v46
    v_mul_f32 v39, v175, v39
    v_mul_f32 v47, v175, v47
    v_mul_f32 v48, v161, v48
    v_mul_f32 v56, v161, v56
    v_mul_f32 v49, v163, v49
    v_mul_f32 v57, v163, v57
    v_mul_f32 v50, v165, v50
    v_mul_f32 v58, v165, v58
    v_mul_f32 v51, v167, v51
    v_mul_f32 v59, v167, v59
    v_mul_f32 v52, v169, v52
    v_mul_f32 v60, v169, v60
    v_mul_f32 v53, v171, v53
    v_mul_f32 v61, v171, v61
    v_mul_f32 v54, v173, v54
    v_mul_f32 v62, v173, v62
    v_mul_f32 v55, v175, v55
    v_mul_f32 v63, v175, v63
    v_mul_f32 v64, v161, v64
    v_mul_f32 v72, v161, v72
    v_mul_f32 v65, v163, v65
    v_mul_f32 v73, v163, v73
    v_mul_f32 v66, v165, v66
    v_mul_f32 v74, v165, v74
    v_mul_f32 v67, v167, v67
    v_mul_f32 v75, v167, v75
    v_mul_f32 v68, v169, v68
    v_mul_f32 v76, v169, v76
    v_mul_f32 v69, v171, v69
    v_mul_f32 v77, v171, v77
    v_mul_f32 v70, v173, v70
    v_mul_f32 v78, v173, v78
    v_mul_f32 v71, v175, v71
    v_mul_f32 v79, v175, v79
    v_mul_f32 v80, v161, v80
    v_mul_f32 v88, v161, v88
    v_mul_f32 v81, v163, v81
    v_mul_f32 v89, v163, v89
    v_mul_f32 v82, v165, v82
    v_mul_f32 v90, v165, v90
    v_mul_f32 v83, v167, v83
    v_mul_f32 v91, v167, v91
    v_mul_f32 v84, v169, v84
    v_mul_f32 v92, v169, v92
    v_mul_f32 v85, v171, v85
    v_mul_f32 v93, v171, v93
    v_mul_f32 v86, v173, v86
    v_mul_f32 v94, v173, v94
    v_mul_f32 v87, v175, v87
    v_mul_f32 v95, v175, v95
    v_fma_f32 v134, v112, v32, v33
    v_fma_f32 v138, v116, v48, v49
    v_fma_f32 v142, v120, v64, v65
    v_fma_f32 v146, v124, v80, v81
    v_fma_f32 v135, v112, v40, v41
    v_fma_f32 v139, v116, v56, v57
    v_fma_f32 v143, v120, v72, v73
    v_fma_f32 v147, v124, v88, v89
    v_fma_f32 v134, -v113, v40, v134
    v_fma_f32 v138, -v117, v56, v138
    v_fma_f32 v142, -v121, v72, v142
    v_fma_f32 v146, -v125, v88, v146
    v_fmac_f32 v135, v113, v32
    v_fmac_f32 v139, v117, v48
    v_fmac_f32 v143, v121, v64
    v_fmac_f32 v147, v125, v80
    v_fma_f32 v132, v112, v134, v34
    v_fma_f32 v136, v116, v138, v50
    v_fma_f32 v140, v120, v142, v66
    v_fma_f32 v144, v124, v146, v82
    v_fma_f32 v133, v112, v135, v42
    v_fma_f32 v137, v116, v139, v58
    v_fma_f32 v141, v120, v143, v74
    v_fma_f32 v145, v124, v147, v90
    v_fma_f32 v132, -v113, v135, v132
    v_fma_f32 v136, -v117, v139, v136
    v_fma_f32 v140, -v121, v143, v140
    v_fma_f32 v144, -v125, v147, v144
    v_fmac_f32 v133, v113, v134
    v_fmac_f32 v137, v117, v138
    v_fmac_f32 v141, v121, v142
    v_fmac_f32 v145, v125, v146
    v_fma_f32 v134, v112, v132, v35
    v_fma_f32 v138, v116, v136, v51
    v_fma_f32 v142, v120, v140, v67
    v_fma_f32 v146, v124, v144, v83
    v_fma_f32 v135, v112, v133, v43
    v_fma_f32 v139, v116, v137, v59
    v_fma_f32 v143, v120, v141, v75
    v_fma_f32 v147, v124, v145, v91
    v_fma_f32 v134, -v113, v133, v134
    v_fma_f32 v138, -v117, v137, v138
    v_fma_f32 v142, -v121, v141, v142
    v_fma_f32 v146, -v125, v145, v146
    v_fmac_f32 v135, v113, v132
    v_fmac_f32 v139, v117, v136
    v_fmac_f32 v143, v121, v140
    v_fmac_f32 v147, v125, v144
    v_fma_f32 v132, v112, v134, v36
    v_fma_f32 v136, v116, v138, v52
    v_fma_f32 v140, v120, v142, v68
    v_fma_f32 v144, v124, v146, v84
    v_fma_f32 v133, v112, v135, v44
    v_fma_f32 v137, v116, v139, v60
    v_fma_f32 v141, v120, v143, v76
    v_fma_f32 v145, v124, v147, v92
    v_fma_f32 v132, -v113, v135, v132
    v_fma_f32 v136, -v117, v139, v136
    v_fma_f32 v140, -v121, v143, v140
    v_fma_f32 v144, -v125, v147, v144
    v_fmac_f32 v133, v113, v134
    v_fmac_f32 v137, v117, v138
    v_fmac_f32 v141, v121, v142
    v_fmac_f32 v145, v125, v146
    v_fma_f32 v134, v112, v132, v37
    v_fma_f32 v138, v116, v136, v53
    v_fma_f32 v142, v120, v140, v69
    v_fma_f32 v146, v124, v144, v85
    v_fma_f32 v135, v112, v133, v45
    v_fma_f32 v139, v116, v137, v61
    v_fma_f32 v143, v120, v141, v77
    v_fma_f32 v147, v124, v145, v93
    v_fma_f32 v134, -v113, v133, v134
    v_fma_f32 v138, -v117, v137, v138
    v_fma_f32 v142, -v121, v141, v142
    v_fma_f32 v146, -v125, v145, v146
    v_fmac_f32 v135, v113, v132
    v_fmac_f32 v139, v117, v136
    v_fmac_f32 v143, v121, v140
    v_fmac_f32 v147, v125, v144
    v_fma_f32 v132, v112, v134, v38
    v_fma_f32 v136, v116, v138, v54
    v_fma_f32 v140, v120, v142, v70
    v_fma_f32 v144, v124, v146, v86
    v_fma_f32 v133, v112, v135, v46
    v_fma_f32 v137, v116, v139, v62
    v_fma_f32 v141, v120, v143, v78
    v_fma_f32 v145, v124, v147, v94
    v_fma_f32 v132, -v113, v135, v132
    v_fma_f32 v136, -v117, v139, v136
    v_fma_f32 v140, -v121, v143, v140
    v_fma_f32 v144, -v125, v147, v144
    v_fmac_f32 v133, v113, v134
    v_fmac_f32 v137, v117, v138
    v_fmac_f32 v141, v121, v142
    v_fmac_f32 v145, v125, v146
    v_fma_f32 v134, v112, v132, v39
    v_fma_f32 v138, v116, v136, v55
    v_fma_f32 v142, v120, v140, v71
    v_fma_f32 v146, v124, v144, v87
    v_fma_f32 v135, v112, v133, v47
    v_fma_f32 v139, v116, v137, v63
    v_fma_f32 v143, v120, v141, v79
    v_fma_f32 v147, v124, v145, v95
    v_fma_f32 v134, -v113, v133, v134
    v_fma_f32 v138, -v117, v137, v138
    v_fma_f32 v142, -v121, v141, v142
    v_fma_f32 v146, -v125, v145, v146
    v_fmac_f32 v135, v113, v132
    v_fmac_f32 v139, v117, v136
    v_fmac_f32 v143, v121, v140
    v_fmac_f32 v147, v125, v144
    ds_write_b64 v12, v[134:135] offset:0
    ds_write_b64 v12, v[138:139] offset:256
    ds_write_b64 v12, v[142:143] offset:512
    ds_write_b64 v12, v[146:147] offset:768
    global_load_dword v21, v20, s[44:45]
    v_subrev_u32 v16, 256, v0
    v_min_u32 v16, 143, v16
    v_lshlrev_b32 v3, 5, v16
    v_add_u32 v3, 158208, v3
    ds_read_b128 v[152:155], v3 offset:16
    v_lshlrev_b32 v16, 3, v16
    v_add_u32 v17, 55296, v16
    s_mul_i32 s75, s81, 18432
    s_add_u32 s75, s75, 42008576
    s_add_u32 s68, s64, s75
    s_addc_u32 s69, s65, 0
    s_mov_b32 s70, 18432
    s_mov_b32 s71, 0x20000
    s_waitcnt vmcnt(2)
    v_cmp_ne_u32 vcc, 1, v19
    s_cbranch_vccz L_s_ci_x
    s_mov_b64 exec, 3
    s_mov_b32 s78, 0x100000
L_s_cir:
    v_mov_b32 v19, 0
    buffer_atomic_or v19, v18, s[28:31], 0 offen sc0
    s_sub_u32 s78, s78, 1
    s_cbranch_scc1 L_s_cir_x
    s_waitcnt vmcnt(0)
    v_cmp_ne_u32 vcc, 1, v19
    s_cbranch_vccnz L_s_cir
L_s_cir_x:
    s_mov_b64 exec, -1
L_s_ci_x:
    s_waitcnt lgkmcnt(0)
    s_setprio 1
    s_barrier
    s_cmp_eq_u32 s3, 7
    s_cbranch_scc1 L_s_x7
    ds_read_b64 v[160:161], v17 offset:0
    ds_read_b64 v[162:163], v17 offset:1152
    ds_read_b64 v[164:165], v17 offset:2304
    ds_read_b64 v[166:167], v17 offset:3456
    ds_read_b64 v[168:169], v17 offset:4608
    ds_read_b64 v[170:171], v17 offset:5760
    ds_read_b64 v[172:173], v17 offset:6912
    ds_read_b64 v[174:175], v17 offset:8064
    ds_read_b64 v[176:177], v17 offset:9216
    ds_read_b64 v[178:179], v17 offset:10368
    ds_read_b64 v[180:181], v17 offset:11520
    ds_read_b64 v[182:183], v17 offset:12672
    ds_read_b64 v[184:185], v17 offset:13824
    ds_read_b64 v[186:187], v17 offset:14976
    ds_read_b64 v[188:189], v17 offset:16128
    ds_read_b64 v[190:191], v17 offset:17280
    v_fma_f32 v158, v152, v160, v162
    v_fma_f32 v159, v152, v161, v163
    v_fma_f32 v158, -v153, v161, v158
    v_fma_f32 v159, v153, v160, v159
    v_fma_f32 v156, v152, v158, v164
    v_fma_f32 v157, v152, v159, v165
    v_fma_f32 v156, -v153, v159, v156
    v_fma_f32 v157, v153, v158, v157
    v_fma_f32 v158, v152, v156, v166
    v_fma_f32 v159, v152, v157, v167
    v_fma_f32 v158, -v153, v157, v158
    v_fma_f32 v159, v153, v156, v159
    v_fma_f32 v156, v152, v158, v168
    v_fma_f32 v157, v152, v159, v169
    v_fma_f32 v156, -v153, v159, v156
    v_fma_f32 v157, v153, v158, v157
    v_fma_f32 v158, v152, v156, v170
    v_fma_f32 v159, v152, v157, v171
    v_fma_f32 v158, -v153, v157, v158
    v_fma_f32 v159, v153, v156, v159
    v_fma_f32 v156, v152, v158, v172
    v_fma_f32 v157, v152, v159, v173
    v_fma_f32 v156, -v153, v159, v156
    v_fma_f32 v157, v153, v158, v157
    v_fma_f32 v158, v152, v156, v174
    v_fma_f32 v159, v152, v157, v175
    v_fma_f32 v158, -v153, v157, v158
    v_fma_f32 v159, v153, v156, v159
    v_fma_f32 v156, v152, v158, v176
    v_fma_f32 v157, v152, v159, v177
    v_fma_f32 v156, -v153, v159, v156
    v_fma_f32 v157, v153, v158, v157
    v_fma_f32 v158, v152, v156, v178
    v_fma_f32 v159, v152, v157, v179
    v_fma_f32 v158, -v153, v157, v158
    v_fma_f32 v159, v153, v156, v159
    v_fma_f32 v156, v152, v158, v180
    v_fma_f32 v157, v152, v159, v181
    v_fma_f32 v156, -v153, v159, v156
    v_fma_f32 v157, v153, v158, v157
    v_fma_f32 v158, v152, v156, v182
    v_fma_f32 v159, v152, v157, v183
    v_fma_f32 v158, -v153, v157, v158
    v_fma_f32 v159, v153, v156, v159
    v_fma_f32 v156, v152, v158, v184
    v_fma_f32 v157, v152, v159, v185
    v_fma_f32 v156, -v153, v159, v156
    v_fma_f32 v157, v153, v158, v157
    v_fma_f32 v158, v152, v156, v186
    v_fma_f32 v159, v152, v157, v187
    v_fma_f32 v158, -v153, v157, v158
    v_fma_f32 v159, v153, v156, v159
    v_fma_f32 v156, v152, v158, v188
    v_fma_f32 v157, v152, v159, v189
    v_fma_f32 v156, -v153, v159, v156
    v_fma_f32 v157, v153, v158, v157
    v_fma_f32 v158, v152, v156, v190
    v_fma_f32 v159, v152, v157, v191
    v_fma_f32 v158, -v153, v157, v158
    v_fma_f32 v159, v153, v156, v159
    s_mul_i32 s75, s6, 1152
    buffer_store_dwordx2 v[158:159], v16, s[68:71], s75 offen sc1
L_s_x7:
    v_mul_f32 v224, v115, v40
    v_mul_f32 v225, v115, v41
    v_mul_f32 v226, v115, v42
    v_mul_f32 v227, v115, v43
    v_mul_f32 v228, v115, v44
    v_mul_f32 v229, v115, v45
    v_mul_f32 v230, v115, v46
    v_mul_f32 v231, v115, v47
    v_mul_f32 v40, v114, v40
    v_mul_f32 v41, v114, v41
    v_mul_f32 v42, v114, v42
    v_mul_f32 v43, v114, v43
    v_mul_f32 v44, v114, v44
    v_mul_f32 v45, v114, v45
    v_mul_f32 v46, v114, v46
    v_mul_f32 v47, v114, v47
    v_fmac_f32 v40, v115, v32
    v_fmac_f32 v41, v115, v33
    v_fmac_f32 v42, v115, v34
    v_fmac_f32 v43, v115, v35
    v_fmac_f32 v44, v115, v36
    v_fmac_f32 v45, v115, v37
    v_fmac_f32 v46, v115, v38
    v_fmac_f32 v47, v115, v39
    v_fma_f32 v32, v114, v32, -v224
    v_fma_f32 v33, v114, v33, -v225
    v_fma_f32 v34, v114, v34, -v226
    v_fma_f32 v35, v114, v35, -v227
    v_fma_f32 v36, v114, v36, -v228
    v_fma_f32 v37, v114, v37, -v229
    v_fma_f32 v38, v114, v38, -v230
    v_fma_f32 v39, v114, v39, -v231
    v_mul_f32 v224, v119, v56
    v_mul_f32 v225, v119, v57
    v_mul_f32 v226, v119, v58
    v_mul_f32 v227, v119, v59
    v_mul_f32 v228, v119, v60
    v_mul_f32 v229, v119, v61
    v_mul_f32 v230, v119, v62
    v_mul_f32 v231, v119, v63
    v_mul_f32 v56, v118, v56
    v_mul_f32 v57, v118, v57
    v_mul_f32 v58, v118, v58
    v_mul_f32 v59, v118, v59
    v_mul_f32 v60, v118, v60
    v_mul_f32 v61, v118, v61
    v_mul_f32 v62, v118, v62
    v_mul_f32 v63, v118, v63
    v_fmac_f32 v56, v119, v48
    v_fmac_f32 v57, v119, v49
    v_fmac_f32 v58, v119, v50
    v_fmac_f32 v59, v119, v51
    v_fmac_f32 v60, v119, v52
    v_fmac_f32 v61, v119, v53
    v_fmac_f32 v62, v119, v54
    v_fmac_f32 v63, v119, v55
    v_fma_f32 v48, v118, v48, -v224
    v_fma_f32 v49, v118, v49, -v225
    v_fma_f32 v50, v118, v50, -v226
    v_fma_f32 v51, v118, v51, -v227
    v_fma_f32 v52, v118, v52, -v228
    v_fma_f32 v53, v118, v53, -v229
    v_fma_f32 v54, v118, v54, -v230
    v_fma_f32 v55, v118, v55, -v231
    v_mul_f32 v224, v123, v72
    v_mul_f32 v225, v123, v73
    v_mul_f32 v226, v123, v74
    v_mul_f32 v227, v123, v75
    v_mul_f32 v228, v123, v76
    v_mul_f32 v229, v123, v77
    v_mul_f32 v230, v123, v78
    v_mul_f32 v231, v123, v79
    v_mul_f32 v72, v122, v72
    v_mul_f32 v73, v122, v73
    v_mul_f32 v74, v122, v74
    v_mul_f32 v75, v122, v75
    v_mul_f32 v76, v122, v76
    v_mul_f32 v77, v122, v77
    v_mul_f32 v78, v122, v78
    v_mul_f32 v79, v122, v79
    v_fmac_f32 v72, v123, v64
    v_fmac_f32 v73, v123, v65
    v_fmac_f32 v74, v123, v66
    v_fmac_f32 v75, v123, v67
    v_fmac_f32 v76, v123, v68
    v_fmac_f32 v77, v123, v69
    v_fmac_f32 v78, v123, v70
    v_fmac_f32 v79, v123, v71
    v_fma_f32 v64, v122, v64, -v224
    v_fma_f32 v65, v122, v65, -v225
    v_fma_f32 v66, v122, v66, -v226
    v_fma_f32 v67, v122, v67, -v227
    v_fma_f32 v68, v122, v68, -v228
    v_fma_f32 v69, v122, v69, -v229
    v_fma_f32 v70, v122, v70, -v230
    v_fma_f32 v71, v122, v71, -v231
    v_mul_f32 v224, v127, v88
    v_mul_f32 v225, v127, v89
    v_mul_f32 v226, v127, v90
    v_mul_f32 v227, v127, v91
    v_mul_f32 v228, v127, v92
    v_mul_f32 v229, v127, v93
    v_mul_f32 v230, v127, v94
    v_mul_f32 v231, v127, v95
    v_mul_f32 v88, v126, v88
    v_mul_f32 v89, v126, v89
    v_mul_f32 v90, v126, v90
    v_mul_f32 v91, v126, v91
    v_mul_f32 v92, v126, v92
    v_mul_f32 v93, v126, v93
    v_mul_f32 v94, v126, v94
    v_mul_f32 v95, v126, v95
    v_fmac_f32 v88, v127, v80
    v_fmac_f32 v89, v127, v81
    v_fmac_f32 v90, v127, v82
    v_fmac_f32 v91, v127, v83
    v_fmac_f32 v92, v127, v84
    v_fmac_f32 v93, v127, v85
    v_fmac_f32 v94, v127, v86
    v_fmac_f32 v95, v127, v87
    v_fma_f32 v80, v126, v80, -v224
    v_fma_f32 v81, v126, v81, -v225
    v_fma_f32 v82, v126, v82, -v226
    v_fma_f32 v83, v126, v83, -v227
    v_fma_f32 v84, v126, v84, -v228
    v_fma_f32 v85, v126, v85, -v229
    v_fma_f32 v86, v126, v86, -v230
    v_fma_f32 v87, v126, v87, -v231
    s_cmp_eq_u32 s3, 7
    s_cbranch_scc1 L_s_x8
    s_mul_i32 s36, s81, 3
    s_add_u32 s36, s36, s3
    s_lshl_b32 s36, s36, 7
    s_add_u32 s36, s36, 41975296
    s_lshl_b32 s37, 1, s6
    v_mov_b32 v22, s37
    s_sub_u32 s37, s37, 1
    s_sub_u32 s75, s75, 17280
    v_add_u32 v23, s75, v16
    s_waitcnt vmcnt(0)
    s_mov_b64 exec, 1
    buffer_atomic_or v22, off, s[20:23], s36
    s_mov_b64 exec, -1
L_s_x8:
    s_and_b32 s76, s3, 1
    s_mul_i32 s77, s76, 320
    s_bfe_u32 s75, s3, 0x10001
    s_mul_i32 s66, s75, 10240
    s_mul_i32 s75, s75, 36864
    v_add_u32 v3, s77, v1
    v_mul_u32_u24 v8, 3277, v3
    v_lshrrev_b32 v8, 16, v8
    v_lshrrev_b32 v20, 2, v8
    v_sub_u32 v20, 0, v20
    v_and_b32 v20, 3, v20
    v_xor_b32 v3, v3, v20
    v_mul_u32_u24 v8, 832, v8
    v_lshl_add_u32 v8, v3, 4, v8
    v_add_u32 v232, s75, v8
    v_add_u32 v3, s77, v1
    v_add_u32 v3, 64, v3
    v_mul_u32_u24 v8, 3277, v3
    v_lshrrev_b32 v8, 16, v8
    v_lshrrev_b32 v20, 2, v8
    v_sub_u32 v20, 0, v20
    v_and_b32 v20, 3, v20
    v_xor_b32 v3, v3, v20
    v_mul_u32_u24 v8, 832, v8
    v_lshl_add_u32 v8, v3, 4, v8
    v_add_u32 v233, s75, v8
    v_add_u32 v3, s77, v1
    v_add_u32 v3, 128, v3
    v_mul_u32_u24 v8, 3277, v3
    v_lshrrev_b32 v8, 16, v8
    v_lshrrev_b32 v20, 2, v8
    v_sub_u32 v20, 0, v20
    v_and_b32 v20, 3, v20
    v_xor_b32 v3, v3, v20
    v_mul_u32_u24 v8, 832, v8
    v_lshl_add_u32 v8, v3, 4, v8
    v_add_u32 v234, s75, v8
    v_add_u32 v3, s77, v1
    v_add_u32 v3, 192, v3
    v_mul_u32_u24 v8, 3277, v3
    v_lshrrev_b32 v8, 16, v8
    v_lshrrev_b32 v20, 2, v8
    v_sub_u32 v20, 0, v20
    v_and_b32 v20, 3, v20
    v_xor_b32 v3, v3, v20
    v_mul_u32_u24 v8, 832, v8
    v_lshl_add_u32 v8, v3, 4, v8
    v_add_u32 v235, s75, v8
    v_add_u32 v3, s77, v1
    v_add_u32 v3, 256, v3
    v_mul_u32_u24 v8, 3277, v3
    v_lshrrev_b32 v8, 16, v8
    v_lshrrev_b32 v20, 2, v8
    v_sub_u32 v20, 0, v20
    v_and_b32 v20, 3, v20
    v_xor_b32 v3, v3, v20
    v_mul_u32_u24 v8, 832, v8
    v_lshl_add_u32 v8, v3, 4, v8
    v_add_u32 v236, s75, v8
    s_mul_i32 s76, s76, 5120
    s_add_u32 s66, s66, s76
    s_and_b32 s85, s85, 0xffffffc0
    s_mov_b32 s12, s42
    s_mov_b32 s13, s43
    s_mov_b32 s14, 663552
    s_mov_b32 s15, 0x20000
    s_mov_b32 s16, s44
    s_mov_b32 s17, s45
    s_mov_b32 s18, 663552
    s_mov_b32 s19, 0x20000
    v_and_b32 v3, 3, v10
    v_lshlrev_b32 v3, 1, v3
    v_bfe_u32 v8, v10, 2, 1
    v_add_u32 v3, v3, v8
    v_and_b32 v8, 8, v10
    v_add_u32 v3, v3, v8
    s_lshl_b32 s76, s4, 2
    v_add_u32 v8, s76, v9
    v_xor_b32 v3, v3, v8
    v_lshlrev_b32 v3, 4, v3
    v_lshl_add_u32 v27, v10, 8, v3
    s_lshl_b32 s76, s5, 13
    s_add_u32 s76, s76, 81920
    v_add_u32 v27, s76, v27
    v_add_u32 v28, 65536, v27
    v_bfe_u32 v3, v1, 2, 2
    v_lshl_add_u32 v8, v9, 3, v3
    v_lshlrev_b32 v240, 8, v8
    v_lshlrev_b32 v3, 1, v3
    v_and_b32 v8, 8, v8
    v_add_u32 v3, v3, v8
    v_bfe_u32 v8, v1, 1, 1
    s_lshl_b32 s76, s4, 2
    v_add_u32 v8, s76, v8
    v_xor_b32 v3, v3, v8
    v_lshl_add_u32 v240, v3, 4, v240
    v_and_b32 v3, 1, v1
    v_lshl_add_u32 v240, v3, 3, v240
    v_add_u32 v240, 81920, v240
    v_xor_b32 v241, 16, v240
    v_xor_b32 v242, 32, v240
    v_xor_b32 v243, 48, v240
    v_lshrrev_b32 v3, 1, v9
    v_lshl_add_u32 v3, v3, 6, v10
    s_lshl_b32 s76, s5, 5
    v_add_u32 v3, s76, v3
    v_mul_u32_u24 v5, 320, v3
    v_lshrrev_b32 v8, 2, v10
    v_sub_u32 v8, 0, v8
    v_and_b32 v8, 3, v8
    s_and_b32 s76, s81, 1
    s_lshl_b32 s76, s76, 1
    v_and_b32 v3, 1, v9
    v_add_u32 v3, s76, v3
    v_xor_b32 v4, v3, v8
    v_lshl_add_u32 v4, v4, 4, v5
    v_add_u32 v3, 2, v3
    v_xor_b32 v3, v3, v8
    v_lshl_add_u32 v5, v3, 4, v5
    s_cmp_eq_u32 s3, 7
    s_cbranch_scc1 L_s_xdone
    v_mov_b32 v3, v23
    s_mov_b32 s78, 0x100000
    s_mov_b64 exec, 1
L_s_poll:
    v_mov_b32 v8, 0
    buffer_atomic_or v8, off, s[20:23], s36 sc0
    s_sub_u32 s78, s78, 1
    s_cbranch_scc1 L_s_poll_x
    s_waitcnt vmcnt(0)
    v_readfirstlane_b32 s74, v8
    s_andn2_b32 s74, s37, s74
    s_cbranch_scc1 L_s_poll
L_s_poll_x:
    s_mov_b64 exec, -1
    v_min_u32 v8, s70, v3
    buffer_load_dwordx2 v[192:193], v8, s[68:71], 0 offen sc1
    v_add_u32 v3, 1152, v3
    v_min_u32 v8, s70, v3
    buffer_load_dwordx2 v[194:195], v8, s[68:71], 0 offen sc1
    v_add_u32 v3, 1152, v3
    v_min_u32 v8, s70, v3
    buffer_load_dwordx2 v[196:197], v8, s[68:71], 0 offen sc1
    v_add_u32 v3, 1152, v3
    v_min_u32 v8, s70, v3
    buffer_load_dwordx2 v[198:199], v8, s[68:71], 0 offen sc1
    v_add_u32 v3, 1152, v3
    v_min_u32 v8, s70, v3
    buffer_load_dwordx2 v[200:201], v8, s[68:71], 0 offen sc1
    v_add_u32 v3, 1152, v3
    v_min_u32 v8, s70, v3
    buffer_load_dwordx2 v[202:203], v8, s[68:71], 0 offen sc1
    v_add_u32 v3, 1152, v3
    v_min_u32 v8, s70, v3
    buffer_load_dwordx2 v[204:205], v8, s[68:71], 0 offen sc1
    v_add_u32 v3, 1152, v3
    v_min_u32 v8, s70, v3
    buffer_load_dwordx2 v[206:207], v8, s[68:71], 0 offen sc1
    v_add_u32 v3, 1152, v3
    v_min_u32 v8, s70, v3
    buffer_load_dwordx2 v[208:209], v8, s[68:71], 0 offen sc1
    v_add_u32 v3, 1152, v3
    v_min_u32 v8, s70, v3
    buffer_load_dwordx2 v[210:211], v8, s[68:71], 0 offen sc1
    v_add_u32 v3, 1152, v3
    v_min_u32 v8, s70, v3
    buffer_load_dwordx2 v[212:213], v8, s[68:71], 0 offen sc1
    v_add_u32 v3, 1152, v3
    v_min_u32 v8, s70, v3
    buffer_load_dwordx2 v[214:215], v8, s[68:71], 0 offen sc1
    v_add_u32 v3, 1152, v3
    v_min_u32 v8, s70, v3
    buffer_load_dwordx2 v[216:217], v8, s[68:71], 0 offen sc1
    v_add_u32 v3, 1152, v3
    v_min_u32 v8, s70, v3
    buffer_load_dwordx2 v[218:219], v8, s[68:71], 0 offen sc1
    v_add_u32 v3, 1152, v3
    v_min_u32 v8, s70, v3
    buffer_load_dwordx2 v[220:221], v8, s[68:71], 0 offen sc1
    s_waitcnt vmcnt(13)
    v_fma_f32 v158, v154, v192, v194
    v_fma_f32 v159, v154, v193, v195
    v_fma_f32 v158, -v155, v193, v158
    v_fma_f32 v159, v155, v192, v159
    s_waitcnt vmcnt(12)
    v_fma_f32 v156, v154, v158, v196
    v_fma_f32 v157, v154, v159, v197
    v_fma_f32 v156, -v155, v159, v156
    v_fma_f32 v157, v155, v158, v157
    s_waitcnt vmcnt(11)
    v_fma_f32 v158, v154, v156, v198
    v_fma_f32 v159, v154, v157, v199
    v_fma_f32 v158, -v155, v157, v158
    v_fma_f32 v159, v155, v156, v159
    s_waitcnt vmcnt(10)
    v_fma_f32 v156, v154, v158, v200
    v_fma_f32 v157, v154, v159, v201
    v_fma_f32 v156, -v155, v159, v156
    v_fma_f32 v157, v155, v158, v157
    s_waitcnt vmcnt(9)
    v_fma_f32 v158, v154, v156, v202
    v_fma_f32 v159, v154, v157, v203
    v_fma_f32 v158, -v155, v157, v158
    v_fma_f32 v159, v155, v156, v159
    s_waitcnt vmcnt(8)
    v_fma_f32 v156, v154, v158, v204
    v_fma_f32 v157, v154, v159, v205
    v_fma_f32 v156, -v155, v159, v156
    v_fma_f32 v157, v155, v158, v157
    s_waitcnt vmcnt(7)
    v_fma_f32 v158, v154, v156, v206
    v_fma_f32 v159, v154, v157, v207
    v_fma_f32 v158, -v155, v157, v158
    v_fma_f32 v159, v155, v156, v159
    s_waitcnt vmcnt(6)
    v_fma_f32 v156, v154, v158, v208
    v_fma_f32 v157, v154, v159, v209
    v_fma_f32 v156, -v155, v159, v156
    v_fma_f32 v157, v155, v158, v157
    s_waitcnt vmcnt(5)
    v_fma_f32 v158, v154, v156, v210
    v_fma_f32 v159, v154, v157, v211
    v_fma_f32 v158, -v155, v157, v158
    v_fma_f32 v159, v155, v156, v159
    s_waitcnt vmcnt(4)
    v_fma_f32 v156, v154, v158, v212
    v_fma_f32 v157, v154, v159, v213
    v_fma_f32 v156, -v155, v159, v156
    v_fma_f32 v157, v155, v158, v157
    s_waitcnt vmcnt(3)
    v_fma_f32 v158, v154, v156, v214
    v_fma_f32 v159, v154, v157, v215
    v_fma_f32 v158, -v155, v157, v158
    v_fma_f32 v159, v155, v156, v159
    s_waitcnt vmcnt(2)
    v_fma_f32 v156, v154, v158, v216
    v_fma_f32 v157, v154, v159, v217
    v_fma_f32 v156, -v155, v159, v156
    v_fma_f32 v157, v155, v158, v157
    s_waitcnt vmcnt(1)
    v_fma_f32 v158, v154, v156, v218
    v_fma_f32 v159, v154, v157, v219
    v_fma_f32 v158, -v155, v157, v158
    v_fma_f32 v159, v155, v156, v159
    s_waitcnt vmcnt(0)
    v_fma_f32 v156, v154, v158, v220
    v_fma_f32 v157, v154, v159, v221
    v_fma_f32 v156, -v155, v159, v156
    v_fma_f32 v157, v155, v158, v157
    ds_write_b64 v17, v[156:157]
    v_fma_f32 v160, v152, v156, v160
    v_fma_f32 v161, v152, v157, v161
    v_fma_f32 v160, -v153, v157, v160
    v_fma_f32 v161, v153, v156, v161
    ds_write_b64 v17, v[160:161] offset:1152
    v_fma_f32 v162, v152, v160, v162
    v_fma_f32 v163, v152, v161, v163
    v_fma_f32 v162, -v153, v161, v162
    v_fma_f32 v163, v153, v160, v163
    ds_write_b64 v17, v[162:163] offset:2304
    v_fma_f32 v164, v152, v162, v164
    v_fma_f32 v165, v152, v163, v165
    v_fma_f32 v164, -v153, v163, v164
    v_fma_f32 v165, v153, v162, v165
    ds_write_b64 v17, v[164:165] offset:3456
    v_fma_f32 v166, v152, v164, v166
    v_fma_f32 v167, v152, v165, v167
    v_fma_f32 v166, -v153, v165, v166
    v_fma_f32 v167, v153, v164, v167
    ds_write_b64 v17, v[166:167] offset:4608
    v_fma_f32 v168, v152, v166, v168
    v_fma_f32 v169, v152, v167, v169
    v_fma_f32 v168, -v153, v167, v168
    v_fma_f32 v169, v153, v166, v169
    ds_write_b64 v17, v[168:169] offset:5760
    v_fma_f32 v170, v152, v168, v170
    v_fma_f32 v171, v152, v169, v171
    v_fma_f32 v170, -v153, v169, v170
    v_fma_f32 v171, v153, v168, v171
    ds_write_b64 v17, v[170:171] offset:6912
    v_fma_f32 v172, v152, v170, v172
    v_fma_f32 v173, v152, v171, v173
    v_fma_f32 v172, -v153, v171, v172
    v_fma_f32 v173, v153, v170, v173
    ds_write_b64 v17, v[172:173] offset:8064
    v_fma_f32 v174, v152, v172, v174
    v_fma_f32 v175, v152, v173, v175
    v_fma_f32 v174, -v153, v173, v174
    v_fma_f32 v175, v153, v172, v175
    ds_write_b64 v17, v[174:175] offset:9216
    v_fma_f32 v176, v152, v174, v176
    v_fma_f32 v177, v152, v175, v177
    v_fma_f32 v176, -v153, v175, v176
    v_fma_f32 v177, v153, v174, v177
    ds_write_b64 v17, v[176:177] offset:10368
    v_fma_f32 v178, v152, v176, v178
    v_fma_f32 v179, v152, v177, v179
    v_fma_f32 v178, -v153, v177, v178
    v_fma_f32 v179, v153, v176, v179
    ds_write_b64 v17, v[178:179] offset:11520
    v_fma_f32 v180, v152, v178, v180
    v_fma_f32 v181, v152, v179, v181
    v_fma_f32 v180, -v153, v179, v180
    v_fma_f32 v181, v153, v178, v181
    ds_write_b64 v17, v[180:181] offset:12672
    v_fma_f32 v182, v152, v180, v182
    v_fma_f32 v183, v152, v181, v183
    v_fma_f32 v182, -v153, v181, v182
    v_fma_f32 v183, v153, v180, v183
    ds_write_b64 v17, v[182:183] offset:13824
    v_fma_f32 v184, v152, v182, v184
    v_fma_f32 v185, v152, v183, v185
    v_fma_f32 v184, -v153, v183, v184
    v_fma_f32 v185, v153, v182, v185
    ds_write_b64 v17, v[184:185] offset:14976
    v_fma_f32 v186, v152, v184, v186
    v_fma_f32 v187, v152, v185, v187
    v_fma_f32 v186, -v153, v185, v186
    v_fma_f32 v187, v153, v184, v187
    ds_write_b64 v17, v[186:187] offset:16128
    v_fma_f32 v188, v152, v186, v188
    v_fma_f32 v189, v152, v187, v189
    v_fma_f32 v188, -v153, v187, v188
    v_fma_f32 v189, v153, v186, v189
    ds_write_b64 v17, v[188:189] offset:17280
L_s_xdone:
    s_setprio 0
    s_add_u32 s85, s85, 73728
    s_waitcnt lgkmcnt(0)
    s_barrier
    ds_read_b64 v[132:133], v12 offset:0
    ds_read_b64 v[136:137], v12 offset:256
    ds_read_b64 v[140:141], v12 offset:512
    ds_read_b64 v[144:145], v12 offset:768
    ds_read_b64 v[148:149], v12 offset:1024
    s_waitcnt lgkmcnt(0)
    v_mul_f32 v134, v114, v132
    v_mul_f32 v135, v114, v133
    v_fma_f32 v134, -v115, v133, v134
    v_fmac_f32 v135, v115, v132
    v_mul_f32 v138, v118, v136
    v_mul_f32 v139, v118, v137
    v_fma_f32 v138, -v119, v137, v138
    v_fmac_f32 v139, v119, v136
    v_mul_f32 v142, v122, v140
    v_mul_f32 v143, v122, v141
    v_fma_f32 v142, -v123, v141, v142
    v_fmac_f32 v143, v123, v140
    v_mul_f32 v146, v126, v144
    v_mul_f32 v147, v126, v145
    v_fma_f32 v146, -v127, v145, v146
    v_fmac_f32 v147, v127, v144
    v_fmac_f32 v32, v112, v134
    v_fmac_f32 v48, v116, v138
    v_fmac_f32 v64, v120, v142
    v_fmac_f32 v80, v124, v146
    v_fmac_f32 v40, v112, v135
    v_fmac_f32 v56, v116, v139
    v_fmac_f32 v72, v120, v143
    v_fmac_f32 v88, v124, v147
    v_fma_f32 v32, -v113, v135, v32
    v_fma_f32 v48, -v117, v139, v48
    v_fma_f32 v64, -v121, v143, v64
    v_fma_f32 v80, -v125, v147, v80
    v_fmac_f32 v40, v113, v134
    v_fmac_f32 v56, v117, v138
    v_fmac_f32 v72, v121, v142
    v_fmac_f32 v88, v125, v146
    v_fmac_f32 v33, v112, v32
    v_fmac_f32 v49, v116, v48
    v_fmac_f32 v65, v120, v64
    v_fmac_f32 v81, v124, v80
    v_fmac_f32 v41, v112, v40
    v_fmac_f32 v57, v116, v56
    v_fmac_f32 v73, v120, v72
    v_fmac_f32 v89, v124, v88
    v_fma_f32 v33, -v113, v40, v33
    v_fma_f32 v49, -v117, v56, v49
    v_fma_f32 v65, -v121, v72, v65
    v_fma_f32 v81, -v125, v88, v81
    v_fmac_f32 v41, v113, v32
    v_fmac_f32 v57, v117, v48
    v_fmac_f32 v73, v121, v64
    v_fmac_f32 v89, v125, v80
    v_fmac_f32 v34, v112, v33
    v_fmac_f32 v50, v116, v49
    v_fmac_f32 v66, v120, v65
    v_fmac_f32 v82, v124, v81
    v_fmac_f32 v42, v112, v41
    v_fmac_f32 v58, v116, v57
    v_fmac_f32 v74, v120, v73
    v_fmac_f32 v90, v124, v89
    v_fma_f32 v34, -v113, v41, v34
    v_fma_f32 v50, -v117, v57, v50
    v_fma_f32 v66, -v121, v73, v66
    v_fma_f32 v82, -v125, v89, v82
    v_fmac_f32 v42, v113, v33
    v_fmac_f32 v58, v117, v49
    v_fmac_f32 v74, v121, v65
    v_fmac_f32 v90, v125, v81
    v_fmac_f32 v35, v112, v34
    v_fmac_f32 v51, v116, v50
    v_fmac_f32 v67, v120, v66
    v_fmac_f32 v83, v124, v82
    v_fmac_f32 v43, v112, v42
    v_fmac_f32 v59, v116, v58
    v_fmac_f32 v75, v120, v74
    v_fmac_f32 v91, v124, v90
    v_fma_f32 v35, -v113, v42, v35
    v_fma_f32 v51, -v117, v58, v51
    v_fma_f32 v67, -v121, v74, v67
    v_fma_f32 v83, -v125, v90, v83
    v_fmac_f32 v43, v113, v34
    v_fmac_f32 v59, v117, v50
    v_fmac_f32 v75, v121, v66
    v_fmac_f32 v91, v125, v82
    v_fmac_f32 v36, v112, v35
    v_fmac_f32 v52, v116, v51
    v_fmac_f32 v68, v120, v67
    v_fmac_f32 v84, v124, v83
    v_fmac_f32 v44, v112, v43
    v_fmac_f32 v60, v116, v59
    v_fmac_f32 v76, v120, v75
    v_fmac_f32 v92, v124, v91
    v_fma_f32 v36, -v113, v43, v36
    v_fma_f32 v52, -v117, v59, v52
    v_fma_f32 v68, -v121, v75, v68
    v_fma_f32 v84, -v125, v91, v84
    v_fmac_f32 v44, v113, v35
    v_fmac_f32 v60, v117, v51
    v_fmac_f32 v76, v121, v67
    v_fmac_f32 v92, v125, v83
    v_fmac_f32 v37, v112, v36
    v_fmac_f32 v53, v116, v52
    v_fmac_f32 v69, v120, v68
    v_fmac_f32 v85, v124, v84
    v_fmac_f32 v45, v112, v44
    v_fmac_f32 v61, v116, v60
    v_fmac_f32 v77, v120, v76
    v_fmac_f32 v93, v124, v92
    v_fma_f32 v37, -v113, v44, v37
    v_fma_f32 v53, -v117, v60, v53
    v_fma_f32 v69, -v121, v76, v69
    v_fma_f32 v85, -v125, v92, v85
    v_fmac_f32 v45, v113, v36
    v_fmac_f32 v61, v117, v52
    v_fmac_f32 v77, v121, v68
    v_fmac_f32 v93, v125, v84
    v_fmac_f32 v38, v112, v37
    v_fmac_f32 v54, v116, v53
    v_fmac_f32 v70, v120, v69
    v_fmac_f32 v86, v124, v85
    v_fmac_f32 v46, v112, v45
    v_fmac_f32 v62, v116, v61
    v_fmac_f32 v78, v120, v77
    v_fmac_f32 v94, v124, v93
    v_fma_f32 v38, -v113, v45, v38
    v_fma_f32 v54, -v117, v61, v54
    v_fma_f32 v70, -v121, v77, v70
    v_fma_f32 v86, -v125, v93, v86
    v_fmac_f32 v46, v113, v37
    v_fmac_f32 v62, v117, v53
    v_fmac_f32 v78, v121, v69
    v_fmac_f32 v94, v125, v85
    v_fmac_f32 v39, v112, v38
    v_fmac_f32 v55, v116, v54
    v_fmac_f32 v71, v120, v70
    v_fmac_f32 v87, v124, v86
    v_fmac_f32 v47, v112, v46
    v_fmac_f32 v63, v116, v62
    v_fmac_f32 v79, v120, v78
    v_fmac_f32 v95, v124, v94
    v_fma_f32 v39, -v113, v46, v39
    v_fma_f32 v55, -v117, v62, v55
    v_fma_f32 v71, -v121, v78, v71
    v_fma_f32 v87, -v125, v94, v87
    v_fmac_f32 v47, v113, v38
    v_fmac_f32 v63, v117, v54
    v_fmac_f32 v79, v121, v70
    v_fmac_f32 v95, v125, v86
    v_cvt_pk_bf16_f32 v160, v32, v33
    v_cvt_pk_bf16_f32 v161, v34, v35
    v_cvt_pk_bf16_f32 v162, v36, v37
    v_cvt_pk_bf16_f32 v163, v38, v39
    v_cvt_pk_bf16_f32 v164, -v40, -v41
    v_cvt_pk_bf16_f32 v165, -v42, -v43
    v_cvt_pk_bf16_f32 v166, -v44, -v45
    v_cvt_pk_bf16_f32 v167, -v46, -v47
    ds_write_b128 v27, v[160:163] offset:0
    ds_write_b128 v27, v[164:167] offset:4096
    v_cvt_pk_bf16_f32 v168, v48, v49
    v_cvt_pk_bf16_f32 v169, v50, v51
    v_cvt_pk_bf16_f32 v170, v52, v53
    v_cvt_pk_bf16_f32 v171, v54, v55
    v_cvt_pk_bf16_f32 v172, -v56, -v57
    v_cvt_pk_bf16_f32 v173, -v58, -v59
    v_cvt_pk_bf16_f32 v174, -v60, -v61
    v_cvt_pk_bf16_f32 v175, -v62, -v63
    ds_write_b128 v27, v[168:171] offset:16384
    ds_write_b128 v27, v[172:175] offset:20480
    v_cvt_pk_bf16_f32 v176, v64, v65
    v_cvt_pk_bf16_f32 v177, v66, v67
    v_cvt_pk_bf16_f32 v178, v68, v69
    v_cvt_pk_bf16_f32 v179, v70, v71
    v_cvt_pk_bf16_f32 v180, -v72, -v73
    v_cvt_pk_bf16_f32 v181, -v74, -v75
    v_cvt_pk_bf16_f32 v182, -v76, -v77
    v_cvt_pk_bf16_f32 v183, -v78, -v79
    ds_write_b128 v27, v[176:179] offset:32768
    ds_write_b128 v27, v[180:183] offset:36864
    v_cvt_pk_bf16_f32 v184, v80, v81
    v_cvt_pk_bf16_f32 v185, v82, v83
    v_cvt_pk_bf16_f32 v186, v84, v85
    v_cvt_pk_bf16_f32 v187, v86, v87
    v_cvt_pk_bf16_f32 v188, -v88, -v89
    v_cvt_pk_bf16_f32 v189, -v90, -v91
    v_cvt_pk_bf16_f32 v190, -v92, -v93
    v_cvt_pk_bf16_f32 v191, -v94, -v95
    ds_write_b128 v27, v[184:187] offset:49152
    ds_write_b128 v27, v[188:191] offset:53248
    s_cmp_eq_u32 s5, 1
    s_cbranch_scc1 L_s_b4
    v_mul_f32 v150, v130, v148
    v_mul_f32 v151, v130, v149
    v_fma_f32 v150, -v131, v149, v150
    v_fmac_f32 v151, v131, v148
    v_fmac_f32 v96, v128, v150
    v_fmac_f32 v104, v128, v151
    v_fma_f32 v96, -v129, v151, v96
    v_fmac_f32 v104, v129, v150
    v_fmac_f32 v97, v128, v96
    v_fmac_f32 v105, v128, v104
    v_fma_f32 v97, -v129, v104, v97
    v_fmac_f32 v105, v129, v96
    v_fmac_f32 v98, v128, v97
    v_fmac_f32 v106, v128, v105
    v_fma_f32 v98, -v129, v105, v98
    v_fmac_f32 v106, v129, v97
    v_fmac_f32 v99, v128, v98
    v_fmac_f32 v107, v128, v106
    v_fma_f32 v99, -v129, v106, v99
    v_fmac_f32 v107, v129, v98
    v_fmac_f32 v100, v128, v99
    v_fmac_f32 v108, v128, v107
    v_fma_f32 v100, -v129, v107, v100
    v_fmac_f32 v108, v129, v99
    v_fmac_f32 v101, v128, v100
    v_fmac_f32 v109, v128, v108
    v_fma_f32 v101, -v129, v108, v101
    v_fmac_f32 v109, v129, v100
    v_fmac_f32 v102, v128, v101
    v_fmac_f32 v110, v128, v109
    v_fma_f32 v102, -v129, v109, v102
    v_fmac_f32 v110, v129, v101
    v_fmac_f32 v103, v128, v102
    v_fmac_f32 v111, v128, v110
    v_fma_f32 v103, -v129, v110, v103
    v_fmac_f32 v111, v129, v102
    v_cvt_pk_bf16_f32 v192, v96, v97
    v_cvt_pk_bf16_f32 v193, v98, v99
    v_cvt_pk_bf16_f32 v194, v100, v101
    v_cvt_pk_bf16_f32 v195, v102, v103
    v_cvt_pk_bf16_f32 v196, -v104, -v105
    v_cvt_pk_bf16_f32 v197, -v106, -v107
    v_cvt_pk_bf16_f32 v198, -v108, -v109
    v_cvt_pk_bf16_f32 v199, -v110, -v111
    ds_write_b128 v28, v[192:195] offset:0
    ds_write_b128 v28, v[196:199] offset:4096
L_s_b4:
    s_waitcnt vmcnt(0) lgkmcnt(0)
    s_barrier
    s_cmp_lt_u32 s93, 4
    s_cbranch_scc1 L_s_nb1
    s_add_u32 m0, s66, 61440
    s_nop 0
    buffer_load_dwordx4 v232, s[16:19], s85 offen  lds
    s_add_u32 m0, s66, 62464
    s_nop 0
    buffer_load_dwordx4 v233, s[16:19], s85 offen  lds
    s_add_u32 m0, s66, 63488
    s_nop 0
    buffer_load_dwordx4 v234, s[16:19], s85 offen  lds
    s_add_u32 m0, s66, 64512
    s_nop 0
    buffer_load_dwordx4 v235, s[16:19], s85 offen  lds
    s_add_u32 m0, s66, 65536
    s_nop 0
    buffer_load_dwordx4 v236, s[16:19], s85 offen  lds
    s_add_u32 m0, s66, 40960
    s_nop 0
    buffer_load_dwordx4 v232, s[12:15], s85 offen  lds
    s_add_u32 m0, s66, 41984
    s_nop 0
    buffer_load_dwordx4 v233, s[12:15], s85 offen  lds
    s_add_u32 m0, s66, 43008
    s_nop 0
    buffer_load_dwordx4 v234, s[12:15], s85 offen  lds
    s_add_u32 m0, s66, 44032
    s_nop 0
    buffer_load_dwordx4 v235, s[12:15], s85 offen  lds
    s_add_u32 m0, s66, 45056
    s_nop 0
    buffer_load_dwordx4 v236, s[12:15], s85 offen  lds
L_s_nb1:
    s_add_u32 s85, s85, 73728
    ds_read_b128 v[64:67], v4 offset:0
    ds_read_b64_tr_b16 v[160:161], v240 offset:0
    ds_read_b64_tr_b16 v[162:163], v241 offset:1024
    ds_read_b128 v[68:71], v4 offset:5120
    ds_read_b64_tr_b16 v[164:165], v242 offset:0
    ds_read_b64_tr_b16 v[166:167], v243 offset:1024
    ds_read_b64_tr_b16 v[168:169], v240 offset:8192
    ds_read_b64_tr_b16 v[170:171], v241 offset:9216
    ds_read_b128 v[72:75], v5 offset:0
    ds_read_b64_tr_b16 v[172:173], v242 offset:8192
    ds_read_b64_tr_b16 v[174:175], v243 offset:9216
    ds_read_b64_tr_b16 v[176:177], v240 offset:16384
    ds_read_b64_tr_b16 v[178:179], v241 offset:17408
    ds_read_b128 v[76:79], v5 offset:5120
    ds_read_b64_tr_b16 v[180:181], v242 offset:16384
    ds_read_b64_tr_b16 v[182:183], v243 offset:17408
    ds_read_b64_tr_b16 v[184:185], v240 offset:24576
    ds_read_b64_tr_b16 v[186:187], v241 offset:25600
    s_waitcnt lgkmcnt(12)
    v_mfma_f32_16x16x32_bf16 v[32:35], v[64:67], v[160:163], 0
    ds_read_b128 v[80:83], v4 offset:64
    v_mfma_f32_16x16x32_bf16 v[40:43], v[64:67], v[164:167], 0
    ds_read_b64_tr_b16 v[188:189], v242 offset:24576
    ds_read_b64_tr_b16 v[190:191], v243 offset:25600
    v_mfma_f32_16x16x32_bf16 v[44:47], v[68:71], v[164:167], 0
    ds_read_b128 v[84:87], v4 offset:5184
    ds_read_b64_tr_b16 v[192:193], v240 offset:32768
    ds_read_b64_tr_b16 v[194:195], v241 offset:33792
    v_mfma_f32_16x16x32_bf16 v[36:39], v[68:71], v[160:163], 0
    ds_read_b64_tr_b16 v[196:197], v242 offset:32768
    ds_read_b64_tr_b16 v[198:199], v243 offset:33792
    s_waitcnt lgkmcnt(12)
    v_mfma_f32_16x16x32_bf16 v[32:35], v[72:75], v[168:171], v[32:35]
    ds_read_b128 v[64:67], v5 offset:64
    ds_read_b64_tr_b16 v[200:201], v240 offset:40960
    ds_read_b64_tr_b16 v[202:203], v241 offset:41984
    v_mfma_f32_16x16x32_bf16 v[40:43], v[72:75], v[172:175], v[40:43]
    ds_read_b64_tr_b16 v[204:205], v242 offset:40960
    ds_read_b64_tr_b16 v[206:207], v243 offset:41984
    v_mfma_f32_16x16x32_bf16 v[44:47], v[76:79], v[172:175], v[44:47]
    ds_read_b128 v[68:71], v5 offset:5184
    ds_read_b64_tr_b16 v[208:209], v240 offset:49152
    ds_read_b64_tr_b16 v[210:211], v241 offset:50176
    v_mfma_f32_16x16x32_bf16 v[36:39], v[76:79], v[168:171], v[36:39]
    ds_read_b64_tr_b16 v[212:213], v242 offset:49152
    ds_read_b64_tr_b16 v[214:215], v243 offset:50176
    s_waitcnt lgkmcnt(14)
    v_mfma_f32_16x16x32_bf16 v[32:35], v[80:83], v[176:179], v[32:35]
    ds_read_b128 v[72:75], v4 offset:128
    ds_read_b64_tr_b16 v[216:217], v240 offset:57344
    ds_read_b64_tr_b16 v[218:219], v241 offset:58368
    v_mfma_f32_16x16x32_bf16 v[40:43], v[80:83], v[180:183], v[40:43]
    ds_read_b64_tr_b16 v[220:221], v242 offset:57344
    ds_read_b64_tr_b16 v[222:223], v243 offset:58368
    v_mfma_f32_16x16x32_bf16 v[44:47], v[84:87], v[180:183], v[44:47]
    ds_read_b128 v[76:79], v4 offset:5248
    v_add_u32 v240, 8192, v240
    v_add_u32 v241, 8192, v241
    v_add_u32 v242, 8192, v242
    v_add_u32 v243, 8192, v243
    ds_read_b64_tr_b16 v[224:225], v240 offset:57344
    ds_read_b64_tr_b16 v[226:227], v241 offset:58368
    v_mfma_f32_16x16x32_bf16 v[36:39], v[84:87], v[176:179], v[36:39]
    ds_read_b64_tr_b16 v[228:229], v242 offset:57344
    ds_read_b64_tr_b16 v[230:231], v243 offset:58368
    s_waitcnt lgkmcnt(14)
    v_mfma_f32_16x16x32_bf16 v[32:35], v[64:67], v[184:187], v[32:35]
    ds_read_b128 v[80:83], v5 offset:128
    v_mfma_f32_16x16x32_bf16 v[40:43], v[64:67], v[188:191], v[40:43]
    v_mfma_f32_16x16x32_bf16 v[44:47], v[68:71], v[188:191], v[44:47]
    ds_read_b128 v[84:87], v5 offset:5248
    v_mfma_f32_16x16x32_bf16 v[36:39], v[68:71], v[184:187], v[36:39]
    s_waitcnt lgkmcnt(2)
    s_barrier
    v_mfma_f32_16x16x32_bf16 v[32:35], v[72:75], v[192:195], v[32:35]
    ds_read_b128 v[64:67], v4 offset:192
    v_mfma_f32_16x16x32_bf16 v[40:43], v[72:75], v[196:199], v[40:43]
    v_lshlrev_b32 v30, 4, v1
    s_lshl_b32 s76, s6, 4
    s_add_u32 s76, s76, s7
    s_mul_i32 s76, s76, 9216
    s_lshl_b32 s77, s93, 10
    s_add_u32 s75, s76, s77
    s_add_u32 m0, s77, 147456
    s_nop 0
    buffer_load_dwordx4 v30, s[8:11], s75 offen  lds
    s_cmp_gt_u32 s93, 4
    s_cbranch_scc1 L_bd17
    s_cmp_lg_u32 s93, 4
    s_cbranch_scc1 L_bd17v
    s_mov_b32 m0, 155648
    s_add_u32 s75, s76, 8192
    buffer_load_dwordx4 v30, s[8:11], s75 offen lds
    s_branch L_bd17
L_bd17v:
    s_bitcmp1_b32 s93, 1
    s_cselect_b32 s68, s58, s48
    s_cselect_b32 s69, s59, s49
    s_mov_b32 s70, 1152
    s_mov_b32 s71, 0x20000
    s_and_b32 s75, s77, 1024
    s_add_u32 m0, s77, 158208
    s_nop 0
    buffer_load_dwordx4 v30, s[68:71], s75 offen  lds
L_bd17:
    v_mfma_f32_16x16x32_bf16 v[44:47], v[76:79], v[196:199], v[44:47]
    ds_read_b128 v[68:71], v4 offset:5312
    v_mfma_f32_16x16x32_bf16 v[36:39], v[76:79], v[192:195], v[36:39]
    s_cmp_lt_u32 s93, 4
    s_cbranch_scc1 L_s_nb2
    s_add_u32 m0, s66, 102400
    s_nop 0
    buffer_load_dwordx4 v232, s[16:19], s85 offen  lds
    s_add_u32 m0, s66, 103424
    s_nop 0
    buffer_load_dwordx4 v233, s[16:19], s85 offen  lds
    s_add_u32 m0, s66, 104448
    s_nop 0
    buffer_load_dwordx4 v234, s[16:19], s85 offen  lds
    s_add_u32 m0, s66, 105472
    s_nop 0
    buffer_load_dwordx4 v235, s[16:19], s85 offen  lds
    s_add_u32 m0, s66, 106496
    s_nop 0
    buffer_load_dwordx4 v236, s[16:19], s85 offen  lds
    s_add_u32 m0, s66, 81920
    s_nop 0
    buffer_load_dwordx4 v232, s[12:15], s85 offen  lds
    s_add_u32 m0, s66, 82944
    s_nop 0
    buffer_load_dwordx4 v233, s[12:15], s85 offen  lds
    s_add_u32 m0, s66, 83968
    s_nop 0
    buffer_load_dwordx4 v234, s[12:15], s85 offen  lds
    s_add_u32 m0, s66, 84992
    s_nop 0
    buffer_load_dwordx4 v235, s[12:15], s85 offen  lds
    s_add_u32 m0, s66, 86016
    s_nop 0
    buffer_load_dwordx4 v236, s[12:15], s85 offen  lds
L_s_nb2:
    s_waitcnt lgkmcnt(2)
    v_mfma_f32_16x16x32_bf16 v[32:35], v[80:83], v[200:203], v[32:35]
    ds_read_b128 v[72:75], v5 offset:192
    v_mfma_f32_16x16x32_bf16 v[40:43], v[80:83], v[204:207], v[40:43]
    v_mfma_f32_16x16x32_bf16 v[44:47], v[84:87], v[204:207], v[44:47]
    ds_read_b128 v[76:79], v5 offset:5312
    v_mfma_f32_16x16x32_bf16 v[36:39], v[84:87], v[200:203], v[36:39]
    s_waitcnt lgkmcnt(2)
    v_mfma_f32_16x16x32_bf16 v[32:35], v[64:67], v[208:211], v[32:35]
    ds_read_b128 v[80:83], v4 offset:256
    v_mfma_f32_16x16x32_bf16 v[40:43], v[64:67], v[212:215], v[40:43]
    v_mfma_f32_16x16x32_bf16 v[44:47], v[68:71], v[212:215], v[44:47]
    ds_read_b128 v[84:87], v4 offset:5376
    v_mfma_f32_16x16x32_bf16 v[36:39], v[68:71], v[208:211], v[36:39]
    v_lshrrev_b32 v28, 5, v1
    v_lshlrev_b32 v8, 6, v28
    v_bfe_u32 v28, v1, 3, 2
    v_lshl_add_u32 v8, v28, 3, v8
    v_and_b32 v28, 7, v1
    s_lshl_b32 s76, s7, 3
    s_lshl_b32 s100, s6, 7
    s_add_u32 s76, s76, s100
    v_add_u32 v28, s76, v28
    v_mul_u32_u24 v31, 1152, v28
    v_add_u32 v31, v31, v8
    s_lshl_b32 s100, s100, 4
    s_add_u32 s100, s100, 41943040
    s_mov_b32 s92, s93
    s_lshl_b32 s76, s6, 4
    s_add_u32 s76, s76, s7
    s_mul_i32 s76, s76, 9
    s_add_u32 s76, s76, s92
    s_lshl_b32 s101, s76, 14
    s_sub_u32 s98, 6, s92
    s_max_i32 s98, s98, -1
    s_mov_b32 s99, 0
    v_mov_b32 v28, 0
    s_mov_b32 s82, 0
    s_mov_b32 s78, 8
    s_cmp_lt_u32 s93, 4
    s_cbranch_scc1 L_s2A_entry
L_s2B_entry:
    s_add_u32 s83, s82, s66
    s_add_u32 s82, s82, 40960
    s_cmp_ge_u32 s82, 122880
    s_cselect_b32 s82, 0, s82
    v_add_u32 v6, s82, v4
    v_add_u32 v7, s82, v5
    s_add_u32 s85, s85, 73728
    s_waitcnt vmcnt(10)
.p2align 3
L_s2B:
    s_waitcnt lgkmcnt(0)
    s_setprio 1
    s_barrier
    s_cmp_le_u32 s78, 2
    s_cbranch_scc1 L_s2_ndB0
    s_add_u32 m0, s83, 20480
    s_nop 0
    buffer_load_dwordx4 v232, s[16:19], s85 offen  lds
    s_add_u32 m0, s83, 21504
    s_nop 0
    buffer_load_dwordx4 v233, s[16:19], s85 offen  lds
    s_add_u32 m0, s83, 22528
    s_nop 0
    buffer_load_dwordx4 v234, s[16:19], s85 offen  lds
L_s2_ndB0:
    v_mfma_f32_16x16x32_bf16 v[32:35], v[72:75], v[216:219], v[32:35]
    ds_read_b128 v[64:67], v6 offset:0
    v_mfma_f32_16x16x32_bf16 v[40:43], v[72:75], v[220:223], v[40:43]
    v_mfma_f32_16x16x32_bf16 v[44:47], v[76:79], v[220:223], v[44:47]
    ds_read_b128 v[68:71], v6 offset:5120
    v_mfma_f32_16x16x32_bf16 v[36:39], v[76:79], v[216:219], v[36:39]
    v_mfma_f32_16x16x32_bf16 v[48:51], v[80:83], v[224:227], v[32:35]
    ds_read_b128 v[72:75], v7 offset:0
    v_mfma_f32_16x16x32_bf16 v[56:59], v[80:83], v[228:231], v[40:43]
    v_mfma_f32_16x16x32_bf16 v[60:63], v[84:87], v[228:231], v[44:47]
    ds_read_b128 v[76:79], v7 offset:5120
    v_mfma_f32_16x16x32_bf16 v[52:55], v[84:87], v[224:227], v[36:39]
    s_setprio 0
    s_sub_u32 s77, 7, s78
    s_cmp_lg_u32 s93, 7
    s_cbranch_scc1 L_fs20
    s_cmp_lt_i32 s77, 0
    s_cbranch_scc1 L_fs20
    s_lshl_b32 s77, s77, 7
    s_add_u32 s77, s77, s100
    v_mov_b32 v9, 1
    s_mov_b64 exec, 1
    buffer_atomic_add v9, off, s[20:23], s77 offset:0
    s_mov_b64 exec, -1
L_fs20:
    v_readfirstlane_b32 s99, v28
    s_lshr_b32 s99, s99, 4
    s_cbranch_scc1 L_s2_nofl
    s_cmp_gt_i32 s78, s98
    s_cbranch_scc1 L_fl21
    s_lshl_b32 s77, s92, 7
    s_add_u32 s77, s77, s100
    v_mov_b32 v28, 0
    s_mov_b64 exec, 1
    buffer_atomic_add v28, off, s[20:23], s77 sc0
    s_mov_b64 exec, -1
L_fl21:
L_s2_nofl:
    s_nop 1
    v_cvt_pk_bf16_f32 v48, v48, v49
    v_cvt_pk_bf16_f32 v49, v50, v51
    v_cvt_pk_bf16_f32 v50, v52, v53
    v_cvt_pk_bf16_f32 v51, v54, v55
    s_add_u32 s75, s84, 0
    buffer_store_dwordx4 v[48:51], v13, s[20:23], s75 offen sc1
    v_cvt_pk_bf16_f32 v56, v56, v57
    v_cvt_pk_bf16_f32 v57, v58, v59
    v_cvt_pk_bf16_f32 v58, v60, v61
    v_cvt_pk_bf16_f32 v59, v62, v63
    s_add_u32 s75, s84, s89
    buffer_store_dwordx4 v[56:59], v13, s[20:23], s75 offen sc1
    s_add_u32 s84, s84, 16384
    s_cmp_eq_u32 s99, 0
    s_cbranch_scc1 L_s2_nop
    s_add_u32 s76, s101, 0
    buffer_load_dwordx4 v[96:99], v30, s[20:23], s76 offen offset:0 sc1
    buffer_load_dwordx4 v[100:103], v30, s[20:23], s76 offen offset:1024 sc1
    buffer_load_dwordx4 v[104:107], v30, s[20:23], s76 offen offset:2048 sc1
    buffer_load_dwordx4 v[108:111], v30, s[20:23], s76 offen offset:3072 sc1
    s_add_u32 s76, s101, 4096
    buffer_load_dwordx4 v[112:115], v30, s[20:23], s76 offen offset:0 sc1
    buffer_load_dwordx4 v[116:119], v30, s[20:23], s76 offen offset:1024 sc1
    buffer_load_dwordx4 v[120:123], v30, s[20:23], s76 offen offset:2048 sc1
    buffer_load_dwordx4 v[124:127], v30, s[20:23], s76 offen offset:3072 sc1
    s_add_u32 s76, s101, 8192
    buffer_load_dwordx4 v[128:131], v30, s[20:23], s76 offen offset:0 sc1
    buffer_load_dwordx4 v[132:135], v30, s[20:23], s76 offen offset:1024 sc1
    buffer_load_dwordx4 v[136:139], v30, s[20:23], s76 offen offset:2048 sc1
    buffer_load_dwordx4 v[140:143], v30, s[20:23], s76 offen offset:3072 sc1
    s_add_u32 s76, s101, 12288
    buffer_load_dwordx4 v[144:147], v30, s[20:23], s76 offen offset:0 sc1
    buffer_load_dwordx4 v[148:151], v30, s[20:23], s76 offen offset:1024 sc1
    buffer_load_dwordx4 v[152:155], v30, s[20:23], s76 offen offset:2048 sc1
    buffer_load_dwordx4 v[156:159], v30, s[20:23], s76 offen offset:3072 sc1
    s_mov_b32 s98, -2
    v_mov_b32 v28, 0
L_s2_nop:
    s_cmp_le_u32 s78, 2
    s_cbranch_scc1 L_s2_ndB
    s_add_u32 m0, s83, 23552
    s_nop 0
    buffer_load_dwordx4 v235, s[16:19], s85 offen  lds
    s_add_u32 m0, s83, 24576
    s_nop 0
    buffer_load_dwordx4 v236, s[16:19], s85 offen  lds
    s_add_u32 m0, s83, 0
    s_nop 0
    buffer_load_dwordx4 v232, s[12:15], s85 offen  lds
    s_add_u32 m0, s83, 1024
    s_nop 0
    buffer_load_dwordx4 v233, s[12:15], s85 offen  lds
L_s2_ndB:
    s_waitcnt lgkmcnt(2)
    v_mfma_f32_16x16x32_bf16 v[32:35], v[64:67], v[160:163], 0
    ds_read_b128 v[80:83], v6 offset:64
    v_mfma_f32_16x16x32_bf16 v[40:43], v[64:67], v[164:167], 0
    v_mfma_f32_16x16x32_bf16 v[44:47], v[68:71], v[164:167], 0
    ds_read_b128 v[84:87], v6 offset:5184
    v_mfma_f32_16x16x32_bf16 v[36:39], v[68:71], v[160:163], 0
    s_waitcnt lgkmcnt(2)
    v_mfma_f32_16x16x32_bf16 v[32:35], v[72:75], v[168:171], v[32:35]
    ds_read_b128 v[64:67], v7 offset:64
    v_mfma_f32_16x16x32_bf16 v[40:43], v[72:75], v[172:175], v[40:43]
    v_mfma_f32_16x16x32_bf16 v[44:47], v[76:79], v[172:175], v[44:47]
    ds_read_b128 v[68:71], v7 offset:5184
    v_mfma_f32_16x16x32_bf16 v[36:39], v[76:79], v[168:171], v[36:39]
    s_waitcnt lgkmcnt(2)
    v_mfma_f32_16x16x32_bf16 v[32:35], v[80:83], v[176:179], v[32:35]
    ds_read_b128 v[72:75], v6 offset:128
    v_mfma_f32_16x16x32_bf16 v[40:43], v[80:83], v[180:183], v[40:43]
    v_mfma_f32_16x16x32_bf16 v[44:47], v[84:87], v[180:183], v[44:47]
    ds_read_b128 v[76:79], v6 offset:5248
    v_mfma_f32_16x16x32_bf16 v[36:39], v[84:87], v[176:179], v[36:39]
    s_waitcnt lgkmcnt(2)
    v_mfma_f32_16x16x32_bf16 v[32:35], v[64:67], v[184:187], v[32:35]
    ds_read_b128 v[80:83], v7 offset:128
    v_mfma_f32_16x16x32_bf16 v[40:43], v[64:67], v[188:191], v[40:43]
    v_mfma_f32_16x16x32_bf16 v[44:47], v[68:71], v[188:191], v[44:47]
    ds_read_b128 v[84:87], v7 offset:5248
    v_mfma_f32_16x16x32_bf16 v[36:39], v[68:71], v[184:187], v[36:39]
    s_waitcnt lgkmcnt(2)
    v_mfma_f32_16x16x32_bf16 v[32:35], v[72:75], v[192:195], v[32:35]
    ds_read_b128 v[64:67], v6 offset:192
    v_mfma_f32_16x16x32_bf16 v[40:43], v[72:75], v[196:199], v[40:43]
    v_mfma_f32_16x16x32_bf16 v[44:47], v[76:79], v[196:199], v[44:47]
    ds_read_b128 v[68:71], v6 offset:5312
    v_mfma_f32_16x16x32_bf16 v[36:39], v[76:79], v[192:195], v[36:39]
    s_waitcnt lgkmcnt(2)
    v_mfma_f32_16x16x32_bf16 v[32:35], v[80:83], v[200:203], v[32:35]
    ds_read_b128 v[72:75], v7 offset:192
    v_mfma_f32_16x16x32_bf16 v[40:43], v[80:83], v[204:207], v[40:43]
    v_mfma_f32_16x16x32_bf16 v[44:47], v[84:87], v[204:207], v[44:47]
    ds_read_b128 v[76:79], v7 offset:5312
    v_mfma_f32_16x16x32_bf16 v[36:39], v[84:87], v[200:203], v[36:39]
    s_waitcnt lgkmcnt(2)
    v_mfma_f32_16x16x32_bf16 v[32:35], v[64:67], v[208:211], v[32:35]
    ds_read_b128 v[80:83], v6 offset:256
    v_mfma_f32_16x16x32_bf16 v[40:43], v[64:67], v[212:215], v[40:43]
    v_mfma_f32_16x16x32_bf16 v[44:47], v[68:71], v[212:215], v[44:47]
    ds_read_b128 v[84:87], v6 offset:5376
    v_mfma_f32_16x16x32_bf16 v[36:39], v[68:71], v[208:211], v[36:39]
    s_add_u32 s83, s82, s66
    s_add_u32 s82, s82, 40960
    s_cmp_ge_u32 s82, 122880
    s_cselect_b32 s82, 0, s82
    v_add_u32 v6, s82, v4
    v_add_u32 v7, s82, v5
    s_add_u32 s85, s85, 73728
    s_sub_u32 s78, s78, 1
    s_cmp_lg_u32 s99, 0
    s_cbranch_scc1 L_s2_j
    s_cmp_le_u32 s78, 1
    s_cbranch_scc1 L_s2_w2
    s_waitcnt vmcnt(4)
    s_branch L_s2B
L_s2_j:
    s_mov_b32 s99, 0
    s_cmp_le_u32 s78, 1
    s_cbranch_scc1 L_s2_w3
    s_waitcnt vmcnt(20)
    s_branch L_s2B
L_s2_w2:
    s_waitcnt vmcnt(0)
L_s2_w3:
    s_waitcnt vmcnt(16)
    s_cmp_lg_u32 s78, 0
    s_cbranch_scc1 L_s2B
    s_waitcnt lgkmcnt(2)
    v_mfma_f32_16x16x32_bf16 v[32:35], v[72:75], v[216:219], v[32:35]
    v_mfma_f32_16x16x32_bf16 v[40:43], v[72:75], v[220:223], v[40:43]
    v_mfma_f32_16x16x32_bf16 v[44:47], v[76:79], v[220:223], v[44:47]
    v_mfma_f32_16x16x32_bf16 v[36:39], v[76:79], v[216:219], v[36:39]
    s_waitcnt lgkmcnt(0)
    v_mfma_f32_16x16x32_bf16 v[48:51], v[80:83], v[224:227], v[32:35]
    v_mfma_f32_16x16x32_bf16 v[56:59], v[80:83], v[228:231], v[40:43]
    v_mfma_f32_16x16x32_bf16 v[60:63], v[84:87], v[228:231], v[44:47]
    v_mfma_f32_16x16x32_bf16 v[52:55], v[84:87], v[224:227], v[36:39]
    v_readfirstlane_b32 s77, v28
    s_lshr_b32 s77, s77, 4
    s_cbranch_scc1 L_s2_nofl2
    s_cmp_gt_i32 s78, s98
    s_cbranch_scc1 L_fl22
    s_lshl_b32 s77, s92, 7
    s_add_u32 s77, s77, s100
    v_mov_b32 v28, 0
    s_mov_b64 exec, 1
    buffer_atomic_add v28, off, s[20:23], s77 sc0
    s_mov_b64 exec, -1
L_fl22:
L_s2_nofl2:
    s_nop 4
    v_cvt_pk_bf16_f32 v48, v48, v49
    v_cvt_pk_bf16_f32 v49, v50, v51
    v_cvt_pk_bf16_f32 v50, v52, v53
    v_cvt_pk_bf16_f32 v51, v54, v55
    s_add_u32 s75, s84, 0
    buffer_store_dwordx4 v[48:51], v13, s[20:23], s75 offen sc1
    v_cvt_pk_bf16_f32 v56, v56, v57
    v_cvt_pk_bf16_f32 v57, v58, v59
    v_cvt_pk_bf16_f32 v58, v60, v61
    v_cvt_pk_bf16_f32 v59, v62, v63
    s_add_u32 s75, s84, s89
    buffer_store_dwordx4 v[56:59], v13, s[20:23], s75 offen sc1
    s_add_u32 s84, s84, 16384
    s_barrier
L_s2_done:
    s_branch L_reduce
L_s2A_entry:
    s_waitcnt lgkmcnt(2)
    v_mfma_f32_16x16x32_bf16 v[32:35], v[72:75], v[216:219], v[32:35]
    v_mfma_f32_16x16x32_bf16 v[40:43], v[72:75], v[220:223], v[40:43]
    v_mfma_f32_16x16x32_bf16 v[44:47], v[76:79], v[220:223], v[44:47]
    v_mfma_f32_16x16x32_bf16 v[36:39], v[76:79], v[216:219], v[36:39]
    s_waitcnt lgkmcnt(0)
    v_mfma_f32_16x16x32_bf16 v[48:51], v[80:83], v[224:227], v[32:35]
    v_mfma_f32_16x16x32_bf16 v[56:59], v[80:83], v[228:231], v[40:43]
    v_mfma_f32_16x16x32_bf16 v[60:63], v[84:87], v[228:231], v[44:47]
    v_mfma_f32_16x16x32_bf16 v[52:55], v[84:87], v[224:227], v[36:39]
    s_add_u32 s83, s82, s66
    s_add_u32 s82, s82, 40960
    s_cmp_ge_u32 s82, 122880
    s_cselect_b32 s82, 0, s82
    v_add_u32 v6, s82, v4
    v_add_u32 v7, s82, v5
    s_add_u32 s85, s85, 73728
    s_nop 2
    v_cvt_pk_bf16_f32 v48, v48, v49
    v_cvt_pk_bf16_f32 v49, v50, v51
    v_cvt_pk_bf16_f32 v50, v52, v53
    v_cvt_pk_bf16_f32 v51, v54, v55
    s_add_u32 s75, s84, 0
    buffer_store_dwordx4 v[48:51], v13, s[20:23], s75 offen sc1
    v_cvt_pk_bf16_f32 v56, v56, v57
    v_cvt_pk_bf16_f32 v57, v58, v59
    v_cvt_pk_bf16_f32 v58, v60, v61
    v_cvt_pk_bf16_f32 v59, v62, v63
    s_add_u32 s75, s84, s89
    buffer_store_dwordx4 v[56:59], v13, s[20:23], s75 offen sc1
    s_add_u32 s84, s84, 16384
    s_waitcnt vmcnt(12)
.p2align 3
L_s2A:
    s_barrier
    ds_read_b128 v[64:67], v6 offset:0
    ds_read_b128 v[68:71], v6 offset:5120
    ds_read_b128 v[72:75], v7 offset:0
    ds_read_b128 v[76:79], v7 offset:5120
    s_waitcnt lgkmcnt(2)
    v_mfma_f32_16x16x32_bf16 v[32:35], v[64:67], v[160:163], 0
    ds_read_b128 v[80:83], v6 offset:64
    v_mfma_f32_16x16x32_bf16 v[40:43], v[64:67], v[164:167], 0
    v_mfma_f32_16x16x32_bf16 v[44:47], v[68:71], v[164:167], 0
    ds_read_b128 v[84:87], v6 offset:5184
    v_mfma_f32_16x16x32_bf16 v[36:39], v[68:71], v[160:163], 0
    s_waitcnt lgkmcnt(2)
    v_mfma_f32_16x16x32_bf16 v[32:35], v[72:75], v[168:171], v[32:35]
    ds_read_b128 v[64:67], v7 offset:64
    v_mfma_f32_16x16x32_bf16 v[40:43], v[72:75], v[172:175], v[40:43]
    v_mfma_f32_16x16x32_bf16 v[44:47], v[76:79], v[172:175], v[44:47]
    ds_read_b128 v[68:71], v7 offset:5184
    v_mfma_f32_16x16x32_bf16 v[36:39], v[76:79], v[168:171], v[36:39]
    s_waitcnt lgkmcnt(2)
    v_mfma_f32_16x16x32_bf16 v[32:35], v[80:83], v[176:179], v[32:35]
    ds_read_b128 v[72:75], v6 offset:128
    v_mfma_f32_16x16x32_bf16 v[40:43], v[80:83], v[180:183], v[40:43]
    v_mfma_f32_16x16x32_bf16 v[44:47], v[84:87], v[180:183], v[44:47]
    ds_read_b128 v[76:79], v6 offset:5248
    v_mfma_f32_16x16x32_bf16 v[36:39], v[84:87], v[176:179], v[36:39]
    s_waitcnt lgkmcnt(2)
    v_mfma_f32_16x16x32_bf16 v[32:35], v[64:67], v[184:187], v[32:35]
    ds_read_b128 v[80:83], v7 offset:128
    v_mfma_f32_16x16x32_bf16 v[40:43], v[64:67], v[188:191], v[40:43]
    v_mfma_f32_16x16x32_bf16 v[44:47], v[68:71], v[188:191], v[44:47]
    ds_read_b128 v[84:87], v7 offset:5248
    v_mfma_f32_16x16x32_bf16 v[36:39], v[68:71], v[184:187], v[36:39]
    s_waitcnt lgkmcnt(2)
    v_mfma_f32_16x16x32_bf16 v[32:35], v[72:75], v[192:195], v[32:35]
    ds_read_b128 v[64:67], v6 offset:192
    v_mfma_f32_16x16x32_bf16 v[40:43], v[72:75], v[196:199], v[40:43]
    v_mfma_f32_16x16x32_bf16 v[44:47], v[76:79], v[196:199], v[44:47]
    ds_read_b128 v[68:71], v6 offset:5312
    v_mfma_f32_16x16x32_bf16 v[36:39], v[76:79], v[192:195], v[36:39]
    s_waitcnt lgkmcnt(2)
    v_mfma_f32_16x16x32_bf16 v[32:35], v[80:83], v[200:203], v[32:35]
    ds_read_b128 v[72:75], v7 offset:192
    v_mfma_f32_16x16x32_bf16 v[40:43], v[80:83], v[204:207], v[40:43]
    v_mfma_f32_16x16x32_bf16 v[44:47], v[84:87], v[204:207], v[44:47]
    ds_read_b128 v[76:79], v7 offset:5312
    v_mfma_f32_16x16x32_bf16 v[36:39], v[84:87], v[200:203], v[36:39]
    s_waitcnt lgkmcnt(2)
    v_mfma_f32_16x16x32_bf16 v[32:35], v[64:67], v[208:211], v[32:35]
    ds_read_b128 v[80:83], v6 offset:256
    v_mfma_f32_16x16x32_bf16 v[40:43], v[64:67], v[212:215], v[40:43]
    v_mfma_f32_16x16x32_bf16 v[44:47], v[68:71], v[212:215], v[44:47]
    ds_read_b128 v[84:87], v6 offset:5376
    v_mfma_f32_16x16x32_bf16 v[36:39], v[68:71], v[208:211], v[36:39]
    s_waitcnt lgkmcnt(2)
    v_mfma_f32_16x16x32_bf16 v[32:35], v[72:75], v[216:219], v[32:35]
    v_mfma_f32_16x16x32_bf16 v[40:43], v[72:75], v[220:223], v[40:43]
    v_mfma_f32_16x16x32_bf16 v[44:47], v[76:79], v[220:223], v[44:47]
    v_mfma_f32_16x16x32_bf16 v[36:39], v[76:79], v[216:219], v[36:39]
    s_waitcnt lgkmcnt(0)
    v_mfma_f32_16x16x32_bf16 v[48:51], v[80:83], v[224:227], v[32:35]
    v_mfma_f32_16x16x32_bf16 v[56:59], v[80:83], v[228:231], v[40:43]
    v_mfma_f32_16x16x32_bf16 v[60:63], v[84:87], v[228:231], v[44:47]
    v_mfma_f32_16x16x32_bf16 v[52:55], v[84:87], v[224:227], v[36:39]
    s_nop 7
    v_cvt_pk_bf16_f32 v48, v48, v49
    v_cvt_pk_bf16_f32 v49, v50, v51
    v_cvt_pk_bf16_f32 v50, v52, v53
    v_cvt_pk_bf16_f32 v51, v54, v55
    s_add_u32 s75, s84, 0
    buffer_store_dwordx4 v[48:51], v13, s[20:23], s75 offen sc1
    v_cvt_pk_bf16_f32 v56, v56, v57
    v_cvt_pk_bf16_f32 v57, v58, v59
    v_cvt_pk_bf16_f32 v58, v60, v61
    v_cvt_pk_bf16_f32 v59, v62, v63
    s_add_u32 s75, s84, s89
    buffer_store_dwordx4 v[56:59], v13, s[20:23], s75 offen sc1
    s_add_u32 s84, s84, 16384
    s_cmp_le_u32 s78, 2
    s_cbranch_scc1 L_s2_ndA
    s_add_u32 m0, s83, 2048
    s_nop 0
    buffer_load_dwordx4 v234, s[12:15], s85 offen  lds
    s_add_u32 m0, s83, 3072
    s_nop 0
    buffer_load_dwordx4 v235, s[12:15], s85 offen  lds
    s_add_u32 m0, s83, 4096
    s_nop 0
    buffer_load_dwordx4 v236, s[12:15], s85 offen  lds
    s_waitcnt vmcnt(5)
    s_branch L_s2_ndA2
L_s2_ndA:
    s_waitcnt vmcnt(2)
L_s2_ndA2:
    s_cmp_lg_u32 s99, 1
    s_cbranch_scc1 L_s2_nh2
    s_add_u32 s76, s101, 8192
    buffer_load_dwordx4 v[128:131], v30, s[20:23], s76 offen offset:0 sc1
    buffer_load_dwordx4 v[132:135], v30, s[20:23], s76 offen offset:1024 sc1
    buffer_load_dwordx4 v[136:139], v30, s[20:23], s76 offen offset:2048 sc1
    buffer_load_dwordx4 v[140:143], v30, s[20:23], s76 offen offset:3072 sc1
    s_add_u32 s76, s101, 12288
    buffer_load_dwordx4 v[144:147], v30, s[20:23], s76 offen offset:0 sc1
    buffer_load_dwordx4 v[148:151], v30, s[20:23], s76 offen offset:1024 sc1
    buffer_load_dwordx4 v[152:155], v30, s[20:23], s76 offen offset:2048 sc1
    buffer_load_dwordx4 v[156:159], v30, s[20:23], s76 offen offset:3072 sc1
    s_mov_b32 s99, 0
L_s2_nh2:
    s_cmp_gt_i32 s78, s98
    s_cbranch_scc1 L_tp18
    v_cmp_ne_u32 vcc, 16, v28
    s_and_b64 vcc, vcc, 1
    s_cbranch_vccnz L_tp18
    s_add_u32 s76, s101, 0
    buffer_load_dwordx4 v[96:99], v30, s[20:23], s76 offen offset:0 sc1
    buffer_load_dwordx4 v[100:103], v30, s[20:23], s76 offen offset:1024 sc1
    buffer_load_dwordx4 v[104:107], v30, s[20:23], s76 offen offset:2048 sc1
    buffer_load_dwordx4 v[108:111], v30, s[20:23], s76 offen offset:3072 sc1
    s_add_u32 s76, s101, 4096
    buffer_load_dwordx4 v[112:115], v30, s[20:23], s76 offen offset:0 sc1
    buffer_load_dwordx4 v[116:119], v30, s[20:23], s76 offen offset:1024 sc1
    buffer_load_dwordx4 v[120:123], v30, s[20:23], s76 offen offset:2048 sc1
    buffer_load_dwordx4 v[124:127], v30, s[20:23], s76 offen offset:3072 sc1
    s_mov_b32 s98, -2
    s_mov_b32 s99, 1
L_tp18:
    s_sub_u32 s76, s78, 1
    s_cmp_gt_i32 s76, s98
    s_cbranch_scc1 L_fl19
    s_lshl_b32 s77, s92, 7
    s_add_u32 s77, s77, s100
    v_mov_b32 v28, 0
    s_mov_b64 exec, 1
    buffer_atomic_add v28, off, s[20:23], s77 sc0
    s_mov_b64 exec, -1
L_fl19:
    s_add_u32 s83, s82, s66
    s_add_u32 s82, s82, 40960
    s_cmp_ge_u32 s82, 122880
    s_cselect_b32 s82, 0, s82
    v_add_u32 v6, s82, v4
    v_add_u32 v7, s82, v5
    s_add_u32 s85, s85, 73728
    s_sub_u32 s78, s78, 1
    s_cmp_lg_u32 s78, 0
    s_cbranch_scc1 L_s2A
    s_cmp_lg_u32 s99, 1
    s_cbranch_scc1 L_s2_done
    s_add_u32 s76, s101, 8192
    buffer_load_dwordx4 v[128:131], v30, s[20:23], s76 offen offset:0 sc1
    buffer_load_dwordx4 v[132:135], v30, s[20:23], s76 offen offset:1024 sc1
    buffer_load_dwordx4 v[136:139], v30, s[20:23], s76 offen offset:2048 sc1
    buffer_load_dwordx4 v[140:143], v30, s[20:23], s76 offen offset:3072 sc1
    s_add_u32 s76, s101, 12288
    buffer_load_dwordx4 v[144:147], v30, s[20:23], s76 offen offset:0 sc1
    buffer_load_dwordx4 v[148:151], v30, s[20:23], s76 offen offset:1024 sc1
    buffer_load_dwordx4 v[152:155], v30, s[20:23], s76 offen offset:2048 sc1
    buffer_load_dwordx4 v[156:159], v30, s[20:23], s76 offen offset:3072 sc1
    s_branch L_s2_done
L_last:
    s_endpgm
.section .rodata,"a"
.p2align 6
.amdhsa_kernel parallel_sum__ssm_conv_s5__mixer_channel_mlp__prompt_kernel
  .amdhsa_next_free_vgpr 256
  .amdhsa_next_free_sgpr 102
  .amdhsa_accum_offset 256
  .amdhsa_group_segment_fixed_size 0
  .amdhsa_kernarg_size 136
  .amdhsa_user_sgpr_count 2
  .amdhsa_user_sgpr_kernarg_segment_ptr 1
  .amdhsa_system_sgpr_workgroup_id_x 1
.end_amdhsa_kernel
```
